```python
import torch

def _softmax(x, axis=-1):
    return torch.softmax(x, dim=axis)
def _gelu(x):
    return torch.nn.functional.gelu(x, approximate="tanh")
def _silu(x):
    return torch.nn.functional.silu(x)
def _sigmoid(x):
    return torch.sigmoid(x)
def _layernorm(x, axis=-1, eps=1e-5):
    m = x.mean(dim=axis, keepdim=True)
    v = x.var(dim=axis, keepdim=True, unbiased=False)
    return (x - m) / torch.sqrt(v + eps)
def _scatter_add(tgt, idx, src, axis=0):
    return tgt.clone().index_add_(axis, idx, src)
def _segment_sum(src, seg, n):
    out = torch.zeros((n,) + src.shape[1:], dtype=src.dtype)
    return out.index_add_(0, seg, src)
def _pad(x, pw):
    flat = tuple(v for pair in reversed(pw) for v in pair)
    return torch.nn.functional.pad(x, flat)

kernel_name = 'parallel_sum__spectral_fnet__glu_gated_glu__prompt'

def setup_inputs():

    _w = (lambda a: (lambda t: t.to(torch.bfloat16) if t.is_floating_point() else t)(torch.as_tensor(a)))
    def _A_setup():
        B, S, D = 1, 2048, 512
        ns = torch.arange(S)[:, None] * torch.arange(S)[None, :]
        nd = torch.arange(D)[:, None] * torch.arange(D)[None, :]
        Ws_re = torch.cos(-2.0 * torch.pi * ns / S).to(float)
        Ws_im = torch.sin(-2.0 * torch.pi * ns / S).to(float)
        Wd_re = torch.cos(-2.0 * torch.pi * nd / D).to(float)
        Wd_im = torch.sin(-2.0 * torch.pi * nd / D).to(float)
        return {
            "x": _w((lambda *s: torch.randn(*s, dtype=torch.bfloat16) * 0.05)(B, S, D)),
            "dft_seq_re": _w(Ws_re),
            "dft_seq_im": _w(Ws_im),
            "dft_hid_re": _w(Wd_re),
            "dft_hid_im": _w(Wd_im),
        }
    _A_in = _A_setup()

    def _B_setup():
        B, S, D, F = 1, 2048, 512, 1792
        return {
            "x": _w((lambda *s: torch.randn(*s, dtype=torch.bfloat16) * 0.05)(B, S, D)),
            "w_gate": _w((lambda *s: torch.randn(*s, dtype=torch.bfloat16) * 1.6)(D, F)),
            "w_up": _w((lambda *s: torch.randn(*s, dtype=torch.bfloat16) * 0.8)(D, F)),
            "w_down": _w((lambda *s: torch.randn(*s, dtype=torch.bfloat16) * 0.8)(F, D)),
        }
    _B_in = _B_setup()

    return {
        "A_x": _A_in["x"],
        "A_dft_seq_re": _A_in["dft_seq_re"],
        "A_dft_seq_im": _A_in["dft_seq_im"],
        "A_dft_hid_re": _A_in["dft_hid_re"],
        "A_dft_hid_im": _A_in["dft_hid_im"],
        "B_x": _B_in["x"],
        "B_w_gate": _B_in["w_gate"],
        "B_w_up": _B_in["w_up"],
        "B_w_down": _B_in["w_down"],
    }

def reference(A_x, A_dft_seq_re, A_dft_seq_im, A_dft_hid_re, A_dft_hid_im, B_x, B_w_gate, B_w_up, B_w_down):
    def _A_ref(x, dft_seq_re, dft_seq_im, dft_hid_re, dft_hid_im):
        a = torch.einsum("bsd,ed->bse", x, dft_hid_re)
        b = torch.einsum("bsd,ed->bse", x, dft_hid_im)
        y = torch.einsum("ts,bse->bte", dft_seq_re, a) - torch.einsum("ts,bse->bte", dft_seq_im, b)
        return y

    def _B_ref(x, w_gate, w_up, w_down):
        g = torch.einsum("bsd,df->bsf", x, w_gate)
        u = torch.einsum("bsd,df->bsf", x, w_up)
        h = _sigmoid(g) * u
        return torch.einsum("bsf,fd->bsd", h, w_down)

    x = A_x
    xn = _layernorm(x, axis=-1)
    return x + _A_ref(xn, A_dft_seq_re, A_dft_seq_im, A_dft_hid_re, A_dft_hid_im) + _B_ref(xn, B_w_gate, B_w_up, B_w_down)
```

```asm
; @launch grid=(256,1,1) block=(256,1,1) lds=163840
.amdgcn_target "amdgcn-amd-amdhsa--gfx950"
.text
.globl parallel_sum__spectral_fnet__glu_gated_glu__prompt_kernel
.p2align 8
.type parallel_sum__spectral_fnet__glu_gated_glu__prompt_kernel,@function
parallel_sum__spectral_fnet__glu_gated_glu__prompt_kernel:
    s_cmp_ge_u32 s2, 256
    s_cbranch_scc1 END0
    s_load_dwordx16 s[4:19], s[0:1], 0
    s_load_dwordx8 s[20:27], s[0:1], 64
    s_getpc_b64 s[30:31]
    s_lshr_b32 s28, s2, 3
    s_and_b32 s28, s28, 3
    s_lshl_b32 s28, s28, 7
    v_mul_u32_u24 v2, 512, v0
    v_add_u32 v2, s28, v2
    v_cmp_gt_u32 vcc, CODE_END-CODE_PF, v2
    s_nop 1
    s_and_saveexec_b64 s[28:29], vcc
    s_cbranch_execz NOPF
    global_load_dword v255, v2, s[30:31]
NOPF:
    s_mov_b64 exec, s[28:29]
CODE_PF:
    v_lshrrev_b32 v1, 6, v0
    v_and_b32 v0, 63, v0
    v_readfirstlane_b32 s3, v1
    s_and_b32 s54, s2, 1
    s_lshl_b32 s52, s54, 3
    s_bfe_u32 s65, s2, 0x30003
    s_add_u32 s52, s52, s65
    s_bfe_u32 s86, s2, 0x10002
    s_bfe_u32 s54, s2, 0x10001
    s_bfe_u32 s55, s2, 0x10005
    s_cmp_eq_u32 s54, s55
    s_cselect_b32 s87, 3, 7
    s_lshl_b32 s54, s54, 2
    s_lshr_b32 s55, s2, 6
    s_add_u32 s53, s54, s55
    s_cmp_eq_u32 s55, 3
    s_cselect_b32 s53, s87, s53
    s_cmp_eq_u32 s53, 7
    s_cselect_b32 s54, 1, 7
    s_cselect_b32 s53, 14, s53
    s_mul_i32 s54, s54, s86
    s_add_u32 s53, s53, s54
    s_bfe_u32 s65, s2, 0x10003
    s_lshl_b32 s59, s3, 12
    s_cmp_ge_u32 s53, 14
    s_cbranch_scc1 DFT
    v_lshrrev_b32 v38, 3, v0
    v_and_b32 v39, 7, v0
    v_lshrrev_b32 v76, 4, v0
    v_xor_b32 v39, v76, v39
    v_lshlrev_b32 v39, 4, v39
    v_lshl_add_u32 v1, v38, 15, v39
    v_xor_b32 v2, 64, v1
    v_add_u32 v2, 261120, v2
    s_lshl_b32 s87, s52, 11
    s_and_b32 s54, s3, 1
    s_lshl_b32 s55, s54, 10
    s_add_u32 s86, s87, s55
    s_lshr_b32 s55, s3, 1
    s_lshl_b32 s55, s55, 19
    s_add_u32 s86, s86, s55
    s_mul_i32 s54, s54, 57344
    s_lshl_b32 s55, s53, 8
    s_add_u32 s54, s54, s55
    s_mul_i32 s55, s65, 114688
    s_add_u32 s98, s54, s55
    s_sub_u32 s97, s54, s55
    s_add_u32 s97, s97, 114688
    s_bfe_u32 s55, s2, 0x10004
    s_lshl_b32 s72, s55, 7
    s_bfe_u32 s55, s2, 0x10000
    s_lshl_b32 s55, s55, 8
    s_or_b32 s72, s72, s55
    s_lshl_b32 s99, s3, 11
    v_and_b32 v39, 15, v0
    v_lshlrev_b32 v38, 1, v76
    v_xor_b32 v39, v38, v39
    v_lshlrev_b32 v39, 4, v39
    v_mul_u32_u24 v38, 3584, v76
    v_add_u32 v3, v38, v39
    v_add_u32 v4, 13312, v3
    v_xor_b32 v39, 128, v39
    v_add_u32 v38, v38, v39
    v_add_u32 v5, 26624, v38
    v_add_u32 v6, 39936, v38
    s_mov_b32 s30, 0x200000
    s_mov_b32 s31, 0x20000
    s_mov_b32 s34, 0x1c0000
    s_mov_b32 s35, 0x20000
    s_add_u32 m0, s99, 16384
    s_xor_b32 s96, s72, 0
    s_add_u32 s75, s86, s96
    s_mul_i32 s96, s96, 1792
    s_cmp_ge_u32 s3, 2
    s_waitcnt lgkmcnt(0)
    s_mov_b32 s28, s4
    s_mov_b32 s29, s5
    buffer_load_dwordx4 v1, s[28:31], s75 offen lds
    s_cselect_b32 s32, s18, s16
    s_cselect_b32 s33, s19, s17
    buffer_load_dwordx4 v2, s[28:31], s75 offen offset:1024 lds
    s_add_u32 m0, s59, 98304
    s_add_u32 s60, s98, s96
    buffer_load_dwordx4 v3, s[32:35], s60 offen offset:0 lds
    buffer_load_dwordx4 v4, s[32:35], s60 offen offset:1024 lds
    buffer_load_dwordx4 v5, s[32:35], s60 offen offset:2048 lds
    buffer_load_dwordx4 v6, s[32:35], s60 offen offset:3072 lds
    s_mov_b64 exec, 0
    s_cmp_eq_u32 s3, 0
    s_cbranch_scc1 HG0
    s_cmp_eq_u32 s3, 1
    s_cbranch_scc1 HG1
    s_cmp_eq_u32 s3, 2
    s_cbranch_scc1 HG2
    s_branch HG3
HBG:
    s_mov_b64 exec, -1
    s_add_u32 m0, s59, 114688
    s_add_u32 s60, s97, s96
    buffer_load_dwordx4 v3, s[32:35], s60 offen offset:0 lds
    buffer_load_dwordx4 v4, s[32:35], s60 offen offset:1024 lds
    buffer_load_dwordx4 v5, s[32:35], s60 offen offset:2048 lds
    buffer_load_dwordx4 v6, s[32:35], s60 offen offset:3072 lds
    s_lshl_b32 s54, s3, 8
    s_xor_b32 s54, s54, s72
    s_add_u32 s84, s54, s87
    s_xor_b32 s85, s84, 128
    s_lshl_b32 s55, s65, 6
    v_and_b32 v38, 15, v0
    v_lshrrev_b32 v39, 1, v38
    v_xor_b32 v39, v39, v76
    v_lshlrev_b32 v39, 4, v39
    v_lshl_add_u32 v39, v38, 7, v39
    v_xor_b32 v39, s55, v39
    s_add_u32 m0, s99, 24576
    s_xor_b32 s96, s72, 128
    s_add_u32 s75, s86, s96
    s_mul_i32 s96, s96, 1792
    buffer_load_dwordx4 v1, s[28:31], s75 offen lds
    v_add_u32 v11, 16384, v39
    v_xor_b32 v12, 64, v11
    v_bfe_u32 v38, v0, 2, 3
    s_lshl_b32 s54, s3, 1
    v_xor_b32 v38, s54, v38
    v_lshlrev_b32 v38, 5, v38
    v_and_b32 v39, 3, v0
    v_lshl_add_u32 v38, v39, 3, v38
    v_bfe_u32 v39, v0, 2, 2
    v_lshl_add_u32 v38, v39, 8, v38
    v_lshl_add_u32 v7, v76, 11, v38
    buffer_load_dwordx4 v2, s[28:31], s75 offen offset:1024 lds
    v_xor_b32 v8, 32, v7
    v_add_u32 v9, 98304, v7
    v_add_u32 v10, 98304, v8
    v_bfe_u32 v38, v0, 1, 1
    v_lshrrev_b32 v39, 5, v0
    v_xor_b32 v38, v38, v39
    v_add_u32 v38, -1, v38
    v_and_b32 v64, 0x3f803f80, v38
    v_and_b32 v65, 0x3f803f80, v38
    v_and_b32 v66, 0x3f803f80, v38
    v_and_b32 v67, 0x3f803f80, v38
    s_add_u32 m0, s59, 131072
    s_add_u32 s60, s98, s96
    buffer_load_dwordx4 v3, s[32:35], s60 offen offset:0 lds
    v_and_b32 v39, 1, v0
    v_mul_u32_u24 v39, 0xaaaa, v39
    v_or_b32 v13, 0x4444, v39
    v_mov_b32 v56, 0
    v_mov_b32 v57, 0
    v_mov_b32 v58, 0
    v_mov_b32 v59, 0
    v_mov_b32 v60, 0
    v_mov_b32 v61, 0
    v_mov_b32 v62, 0
    v_mov_b32 v63, 0
    buffer_load_dwordx4 v4, s[32:35], s60 offen offset:1024 lds
    s_branch MAIN
DFT:
    s_lshr_b32 s84, s52, 1
    s_and_b32 s54, s52, 1
    s_lshl_b32 s54, s54, 3
    s_add_u32 s84, s84, s54
    s_sub_u32 s85, s53, 14
    v_lshrrev_b32 v38, 3, v0
    v_and_b32 v39, 7, v0
    v_lshlrev_b32 v40, 4, v39
    v_lshl_add_u32 v88, v38, 16, v40
    s_lshl_b32 s54, s84, 2
    s_add_u32 s54, s54, s3
    s_lshl_b32 s86, s54, 10
    s_lshl_b32 s54, s85, 20
    s_add_u32 s86, s86, s54
    s_lshl_b32 s61, s84, 1
    s_add_u32 s61, s61, s85
    s_lshl_b32 s61, s61, 11
    s_add_u32 s61, s61, 12582912
    s_waitcnt lgkmcnt(0)
    s_mov_b32 s28, s4
    s_mov_b32 s29, s5
    s_mov_b32 s30, 0x200000
    s_mov_b32 s31, 0x20000
    s_mov_b32 s40, s26
    s_mov_b32 s41, s27
    s_mov_b32 s42, 0x1000000
    s_mov_b32 s43, 0x20000
    s_cmp_lg_u32 s3, 0
    s_cbranch_scc1 NOCLR
    v_mov_b32 v44, 0
    v_mov_b32 v45, 0
    v_mov_b32 v46, 0
    v_mov_b32 v47, 0
    v_lshlrev_b32 v48, 4, v0
    buffer_store_dwordx4 v[44:47], v48, s[40:43], s61 offen offset:0 sc1
    buffer_store_dwordx4 v[44:47], v48, s[40:43], s61 offen offset:1024 sc1
NOCLR:
    buffer_load_dwordx4 v[128:131], v88, s[28:31], s86 offen offset:0
    buffer_load_dwordx4 v[132:135], v88, s[28:31], s86 offen offset:128
    buffer_load_dwordx4 v[136:139], v88, s[28:31], s86 offen offset:256
    buffer_load_dwordx4 v[140:143], v88, s[28:31], s86 offen offset:384
    buffer_load_dwordx4 v[144:147], v88, s[28:31], s86 offen offset:512
    buffer_load_dwordx4 v[148:151], v88, s[28:31], s86 offen offset:640
    buffer_load_dwordx4 v[152:155], v88, s[28:31], s86 offen offset:768
    buffer_load_dwordx4 v[156:159], v88, s[28:31], s86 offen offset:896
    s_xor_b32 s86, s86, 524288
    buffer_load_dwordx4 v[160:163], v88, s[28:31], s86 offen offset:0
    buffer_load_dwordx4 v[164:167], v88, s[28:31], s86 offen offset:128
    s_mov_b64 exec, 0
    s_cmp_eq_u32 s3, 0
    s_cbranch_scc1 HD0
    s_cmp_eq_u32 s3, 1
    s_cbranch_scc1 HD1
    s_cmp_eq_u32 s3, 2
    s_cbranch_scc1 HD2
    s_branch HD3
HBD:
    s_mov_b64 exec, -1
    s_mov_b32 s32, s10
    s_mov_b32 s33, s11
    s_mov_b32 s34, 0x80000
    s_mov_b32 s35, 0x20000
    s_mov_b32 s36, s12
    s_mov_b32 s37, s13
    s_mov_b32 s38, 0x80000
    s_mov_b32 s39, 0x20000
    v_lshrrev_b32 v40, 1, v38
    v_xor_b32 v40, v40, v39
    v_lshlrev_b32 v40, 4, v40
    v_lshl_add_u32 v1, v38, 11, v40
    v_xor_b32 v40, 64, v1
    v_add_u32 v2, 15360, v40
    v_add_u32 v3, 30720, v1
    v_add_u32 v4, 46080, v40
    s_lshl_b32 s54, s3, 6
    s_add_u32 s54, s54, s85
    s_add_u32 s54, s54, 1
    s_lshl_b32 s87, s54, 10
    v_xor_b32 v5, v38, v39
    v_lshlrev_b32 v5, 4, v5
    v_lshl_add_u32 v5, v39, 8, v5
    s_lshl_b32 s54, s3, 14
    s_add_u32 s54, s54, 16384
    s_lshl_b32 s55, s85, 13
    s_add_u32 s54, s54, s55
    v_add_u32 v5, s54, v5
    s_mov_b32 s56, 0x3f803f80
    v_lshlrev_b32 v18, 4, v38
    v_and_b32 v40, 1, v39
    v_lshl_add_u32 v18, v40, 9, v18
    v_lshrrev_b32 v40, 1, v39
    v_lshl_add_u32 v18, v40, 24, v18
    s_lshl_b32 s54, s84, 2
    s_add_u32 s54, s54, s3
    s_and_b32 s54, s54, 30
    s_lshl_b32 s52, s54, 6
    s_add_u32 s52, s52, 12625920
    s_add_u32 s54, s54, s85
    s_lshl_b32 s60, s54, 10
    s_and_b32 s54, s3, 1
    s_lshl_b32 s54, s54, 8
    s_add_u32 s60, s60, s54
    s_lshr_b32 s54, s84, 3
    s_lshl_b32 s54, s54, 7
    s_add_u32 s60, s60, s54
    s_add_u32 s60, s60, 11534336
    s_mov_b32 s58, 1
    s_cmp_eq_u32 s85, 0
    s_cselect_b32 s96, 0x8000, 0
    s_cselect_b32 s97, 0, -2.0
    s_branch DMAIN
SL_s0:
    s_waitcnt lgkmcnt(0)
    s_cmp_ge_u32 s57, 8
    s_cbranch_scc1 BK_s0
    v_mov_b32 v22, s38
    s_mov_b32 s73, 0
SLL_s0:
    global_load_dword v23, v22, s[26:27]  sc1
    s_waitcnt vmcnt(0)
    v_cmp_gt_u32 vcc, 8, v23
    s_cbranch_vccz BK_s0
    s_sleep 4
    s_add_u32 s73, s73, 1
    s_cmp_lt_u32 s73, 0x20000
    s_cbranch_scc1 SLL_s0
    s_branch BK_s0
SL_clr:
    s_waitcnt lgkmcnt(0)
    s_cmp_ge_u32 s57, 32
    s_cbranch_scc1 BK_clr
    v_mov_b32 v22, 0
    s_mov_b32 s73, 0
SLL_clr:
    global_load_dword v23, v22, s[24:25]  sc1
    s_waitcnt vmcnt(0)
    v_cmp_gt_u32 vcc, 32, v23
    s_cbranch_vccz BK_clr
    s_sleep 4
    s_add_u32 s73, s73, 1
    s_cmp_lt_u32 s73, 0x20000
    s_cbranch_scc1 SLL_clr
    s_branch BK_clr
SL_q0:
    s_waitcnt lgkmcnt(0)
    s_cmp_ge_u32 s57, 14
    s_cbranch_scc1 BK_q0
    v_mov_b32 v22, s53
    s_mov_b32 s73, 0
SLL_q0:
    global_load_dword v23, v22, s[26:27] offset:0 sc1
    s_waitcnt vmcnt(0)
    v_cmp_gt_u32 vcc, 14, v23
    s_cbranch_vccz BK_q0
    s_sleep 1
    s_add_u32 s73, s73, 1
    s_cmp_lt_u32 s73, 0x20000
    s_cbranch_scc1 SLL_q0
    s_branch BK_q0
SL_q1:
    s_waitcnt lgkmcnt(0)
    s_cmp_ge_u32 s57, 14
    s_cbranch_scc1 BK_q1
    v_mov_b32 v22, s53
    s_mov_b32 s73, 0
SLL_q1:
    global_load_dword v23, v22, s[26:27] offset:128 sc1
    s_waitcnt vmcnt(0)
    s_cmp_eq_u32 s56, 0
    s_cbranch_scc1 SLP_q1
    s_mov_b32 s70, 1
    s_mov_b32 s56, 0
    s_atomic_add s70, s[26:27], s52 offset:384
SLP_q1:
    v_cmp_gt_u32 vcc, 14, v23
    s_cbranch_vccz BK_q1
    s_sleep 1
    s_add_u32 s73, s73, 1
    s_cmp_lt_u32 s73, 0x20000
    s_cbranch_scc1 SLL_q1
    s_branch BK_q1
SL_q2:
    s_waitcnt lgkmcnt(0)
    s_cmp_ge_u32 s57, 14
    s_cbranch_scc1 BK_q2
    v_mov_b32 v22, s53
    s_mov_b32 s73, 0
SLL_q2:
    global_load_dword v23, v22, s[26:27] offset:256 sc1
    s_waitcnt vmcnt(0)
    v_cmp_gt_u32 vcc, 14, v23
    s_cbranch_vccz BK_q2
    s_sleep 1
    s_add_u32 s73, s73, 1
    s_cmp_lt_u32 s73, 0x20000
    s_cbranch_scc1 SLL_q2
    s_branch BK_q2
SL_q3:
    s_waitcnt lgkmcnt(0)
    s_cmp_ge_u32 s57, 14
    s_cbranch_scc1 BK_q3
    v_mov_b32 v22, s53
    s_mov_b32 s73, 0
SLL_q3:
    global_load_dword v23, v22, s[26:27] offset:384 sc1
    s_waitcnt vmcnt(0)
    v_cmp_gt_u32 vcc, 14, v23
    s_cbranch_vccz BK_q3
    s_sleep 1
    s_add_u32 s73, s73, 1
    s_cmp_lt_u32 s73, 0x20000
    s_cbranch_scc1 SLL_q3
    s_branch BK_q3
SL_a:
    s_waitcnt lgkmcnt(0)
    s_cmp_ge_u32 s65, 8
    s_cbranch_scc1 BK_a
    v_mov_b32 v22, s74
    s_mov_b32 s73, 0
SLL_a:
    global_load_dword v23, v22, s[26:27]  sc1
    s_waitcnt vmcnt(0)
    v_cmp_gt_u32 vcc, 8, v23
    s_cbranch_vccz BK_a
    s_sleep 4
    s_add_u32 s73, s73, 1
    s_cmp_lt_u32 s73, 0x20000
    s_cbranch_scc1 SLL_a
    s_branch BK_a
SL_ab:
    s_waitcnt lgkmcnt(0)
    s_cmp_ge_u32 s0, 8
    s_cbranch_scc1 BK_ab
    v_mov_b32 v22, s1
    s_mov_b32 s73, 0
SLL_ab:
    global_load_dword v23, v22, s[26:27]  sc1
    s_waitcnt vmcnt(0)
    v_cmp_gt_u32 vcc, 8, v23
    s_cbranch_vccz BK_ab
    s_sleep 4
    s_add_u32 s73, s73, 1
    s_cmp_lt_u32 s73, 0x20000
    s_cbranch_scc1 SLL_ab
    s_branch BK_ab
SL_clrd:
    s_waitcnt lgkmcnt(0)
    s_cmp_ge_u32 s57, 32
    s_cbranch_scc1 BK_clrd
    v_mov_b32 v22, 0
    s_mov_b32 s73, 0
SLL_clrd:
    global_load_dword v23, v22, s[24:25]  sc1
    s_waitcnt vmcnt(0)
    v_cmp_gt_u32 vcc, 32, v23
    s_cbranch_vccz BK_clrd
    s_sleep 4
    s_add_u32 s73, s73, 1
    s_cmp_lt_u32 s73, 0x20000
    s_cbranch_scc1 SLL_clrd
    s_branch BK_clrd
SL_q0d:
    s_waitcnt lgkmcnt(0)
    s_cmp_ge_u32 s57, 14
    s_cbranch_scc1 BK_q0d
    v_mov_b32 v22, s53
    s_mov_b32 s73, 0
SLL_q0d:
    global_load_dword v23, v22, s[26:27] offset:0 sc1
    s_waitcnt vmcnt(0)
    v_cmp_gt_u32 vcc, 14, v23
    s_cbranch_vccz BK_q0d
    s_sleep 1
    s_add_u32 s73, s73, 1
    s_cmp_lt_u32 s73, 0x20000
    s_cbranch_scc1 SLL_q0d
    s_branch BK_q0d
SL_q1d:
    s_waitcnt lgkmcnt(0)
    s_cmp_ge_u32 s57, 14
    s_cbranch_scc1 BK_q1d
    v_mov_b32 v22, s53
    s_mov_b32 s73, 0
SLL_q1d:
    global_load_dword v23, v22, s[26:27] offset:128 sc1
    s_waitcnt vmcnt(0)
    v_cmp_gt_u32 vcc, 14, v23
    s_cbranch_vccz BK_q1d
    s_sleep 1
    s_add_u32 s73, s73, 1
    s_cmp_lt_u32 s73, 0x20000
    s_cbranch_scc1 SLL_q1d
    s_branch BK_q1d
END0:
    s_endpgm
    .p2align 12
MAIN:
HG0:
    s_cbranch_execz HG4
    buffer_load_dwordx4 v5, s[32:35], s60 offen offset:2048 lds
    buffer_load_dwordx4 v6, s[32:35], s60 offen offset:3072 lds
    s_waitcnt vmcnt(10)
    s_barrier
    ds_read_b64_tr_b16 a[0:1], v9 offset:0
    ds_read_b64_tr_b16 a[2:3], v9 offset:1024
    ds_read_b64_tr_b16 a[4:5], v10 offset:0
    ds_read_b64_tr_b16 a[6:7], v10 offset:1024
    ds_read_b64_tr_b16 a[8:9], v9 offset:8192
    ds_read_b64_tr_b16 a[10:11], v9 offset:9216
    ds_read_b64_tr_b16 a[12:13], v10 offset:8192
    ds_read_b64_tr_b16 a[14:15], v10 offset:9216
    ds_read_b128 v[224:227], v11 offset:0
    ds_read_b128 v[228:231], v11 offset:2048
    ds_read_b128 v[232:235], v11 offset:4096
    ds_read_b128 v[236:239], v11 offset:6144
    s_waitcnt lgkmcnt(8)
    v_smfmac_f32_16x16x64_bf16 v[56:59], v[64:67], a[0:7], v13
    s_add_u32 m0, s59, 147456
    s_add_u32 s60, s97, s96
    s_mov_b32 s40, s26
    s_waitcnt lgkmcnt(4)
    v_smfmac_f32_16x16x64_bf16 v[60:63], v[64:67], a[8:15], v13
    s_waitcnt lgkmcnt(3)
    buffer_load_dwordx4 v3, s[32:35], s60 offen offset:0 lds
    s_mov_b32 s41, s27
    v_mfma_f32_16x16x32_bf16 v[144:147], a[0:3], v[224:227], 0
    s_mov_b32 s42, 0x1000000
    s_mov_b32 s43, 0x20000
    s_mov_b32 s44, s20
    v_mfma_f32_16x16x32_bf16 v[148:151], a[4:7], v[224:227], 0
    s_mov_b32 s45, s21
    s_mov_b32 s46, 0x1c0000
    s_mov_b32 s47, 0x20000
    v_mfma_f32_16x16x32_bf16 v[152:155], a[8:11], v[224:227], 0
    buffer_load_dwordx4 v4, s[32:35], s60 offen offset:1024 lds
    s_lshr_b32 s54, s2, 3
    s_and_b32 s55, s54, 3
    v_mfma_f32_16x16x32_bf16 v[156:159], a[12:15], v[224:227], 0
    s_waitcnt lgkmcnt(0)
    s_waitcnt vmcnt(8)
    s_barrier
    v_mfma_f32_16x16x32_bf16 v[160:163], a[0:3], v[228:231], 0
    ds_read_b64_tr_b16 a[16:17], v9 offset:16384
    ds_read_b64_tr_b16 a[18:19], v9 offset:17408
    s_mov_b32 s39, s55
    v_mfma_f32_16x16x32_bf16 v[164:167], a[4:7], v[228:231], 0
    ds_read_b64_tr_b16 a[20:21], v10 offset:16384
    s_add_u32 s55, s55, 24
    s_min_u32 s54, s54, s55
    v_mfma_f32_16x16x32_bf16 v[168:171], a[8:11], v[228:231], 0
    buffer_load_dwordx4 v5, s[32:35], s60 offen offset:2048 lds
    s_lshl_b32 s54, s54, 2
    s_add_u32 s54, s54, s3
    v_mfma_f32_16x16x32_bf16 v[172:175], a[12:15], v[228:231], 0
    ds_read_b64_tr_b16 a[22:23], v10 offset:17408
    ds_read_b64_tr_b16 a[24:25], v9 offset:24576
    s_lshl_b32 s54, s54, 14
    v_mfma_f32_16x16x32_bf16 v[176:179], a[0:3], v[232:235], 0
    ds_read_b64_tr_b16 a[26:27], v9 offset:25600
    ds_read_b64_tr_b16 a[28:29], v10 offset:24576
    s_and_b32 s55, s2, 7
    v_mfma_f32_16x16x32_bf16 v[180:183], a[4:7], v[232:235], 0
    ds_read_b64_tr_b16 a[30:31], v10 offset:25600
    s_lshl_b32 s55, s55, 11
    s_add_u32 s55, s55, s54
    v_mfma_f32_16x16x32_bf16 v[184:187], a[8:11], v[232:235], 0
    buffer_load_dwordx4 v6, s[32:35], s60 offen offset:3072 lds
    s_add_u32 s54, s54, 384
    v_and_b32 v79, 15, v0
    v_mfma_f32_16x16x32_bf16 v[188:191], a[12:15], v[232:235], 0
    ds_read_b128 v[240:243], v12 offset:0
    ds_read_b128 v[244:247], v12 offset:2048
    v_mfma_f32_16x16x32_bf16 v[192:195], a[0:3], v[236:239], 0
    s_add_u32 m0, s99, 32768
    s_xor_b32 s96, s72, 256
    s_add_u32 s75, s86, s96
    s_mul_i32 s96, s96, 1792
    ds_read_b128 v[248:251], v12 offset:4096
    v_mfma_f32_16x16x32_bf16 v[196:199], a[4:7], v[236:239], 0
    buffer_load_dwordx4 v1, s[28:31], s75 offen lds
    v_lshl_add_u32 v77, v79, 10, s54
    v_mfma_f32_16x16x32_bf16 v[200:203], a[8:11], v[236:239], 0
    ds_read_b128 v[252:255], v12 offset:6144
    v_lshl_add_u32 v78, v79, 7, s55
    v_mfma_f32_16x16x32_bf16 v[204:207], a[12:15], v[236:239], 0
    s_waitcnt lgkmcnt(4)
    s_lshr_b32 s54, s54, 14
    s_mul_i32 s54, s54, 8192
    v_smfmac_f32_16x16x64_bf16 v[56:59], v[64:67], a[16:23], v13
    s_add_u32 s54, s54, 655744
    v_min_u32 v79, 7, v0
    v_lshl_add_u32 v77, v79, 10, s54
    v_smfmac_f32_16x16x64_bf16 v[60:63], v[64:67], a[24:31], v13
    s_waitcnt lgkmcnt(3)
    buffer_load_dwordx4 v2, s[28:31], s75 offen offset:1024 lds
    s_lshl_b32 s54, s52, 7
    v_mfma_f32_16x16x32_bf16 v[144:147], a[16:19], v[240:243], v[144:147]
    s_add_u32 s38, s54, 12625920
    s_lshl_b32 s37, s3, 8
    s_add_u32 s36, s87, s37
    s_add_u32 s36, s36, 11534336
    s_add_u32 s37, s37, 81920
    v_lshlrev_b32 v15, 2, v0
    s_cmp_lg_u32 s39, 0
    s_cbranch_scc1 NPF0
    buffer_load_dword v78, v78, s[44:47], 0 offen sc1
NPF0:
    v_mfma_f32_16x16x32_bf16 v[148:151], a[20:23], v[240:243], v[148:151]
    s_add_u32 m0, s59, 0
    s_add_u32 s60, s98, s96
    s_lshl_b32 s54, s52, 5
    v_mfma_f32_16x16x32_bf16 v[152:155], a[24:27], v[240:243], v[152:155]
    buffer_load_dwordx4 v3, s[32:35], s60 offen offset:0 lds
    s_add_u32 s54, s54, s3
    s_mul_i32 s54, s54, 14
    v_mfma_f32_16x16x32_bf16 v[156:159], a[28:31], v[240:243], v[156:159]
    s_waitcnt lgkmcnt(0)
    s_waitcnt vmcnt(7)
    s_barrier
    v_mfma_f32_16x16x32_bf16 v[160:163], a[16:19], v[244:247], v[160:163]
    ds_read_b64_tr_b16 a[32:33], v9 offset:32768
    ds_read_b64_tr_b16 a[34:35], v9 offset:33792
    s_add_u32 s54, s54, s53
    v_mfma_f32_16x16x32_bf16 v[164:167], a[20:23], v[244:247], v[164:167]
    ds_read_b64_tr_b16 a[36:37], v10 offset:32768
    s_lshl_b32 s58, s54, 10
    s_lshl_b32 s54, s52, 2
    v_mfma_f32_16x16x32_bf16 v[168:171], a[24:27], v[244:247], v[168:171]
    buffer_load_dwordx4 v4, s[32:35], s60 offen offset:1024 lds
    s_add_u32 s54, s54, s3
    s_mul_i32 s54, s54, 640
    v_mfma_f32_16x16x32_bf16 v[172:175], a[28:31], v[244:247], v[172:175]
    ds_read_b64_tr_b16 a[38:39], v10 offset:33792
    ds_read_b64_tr_b16 a[40:41], v9 offset:40960
    s_add_u32 s52, s54, 12582912
    v_mfma_f32_16x16x32_bf16 v[176:179], a[16:19], v[248:251], v[176:179]
    ds_read_b64_tr_b16 a[42:43], v9 offset:41984
    ds_read_b64_tr_b16 a[44:45], v10 offset:40960
    s_mov_b32 s56, 1
    v_mfma_f32_16x16x32_bf16 v[180:183], a[20:23], v[248:251], v[180:183]
    ds_read_b64_tr_b16 a[46:47], v10 offset:41984
    v_bfe_u32 v38, v0, 1, 3
    v_mfma_f32_16x16x32_bf16 v[184:187], a[24:27], v[248:251], v[184:187]
    buffer_load_dwordx4 v5, s[32:35], s60 offen offset:2048 lds
    v_lshlrev_b32 v38, 4, v38
    v_mfma_f32_16x16x32_bf16 v[188:191], a[28:31], v[248:251], v[188:191]
    ds_read_b128 v[224:227], v11 offset:8192
    ds_read_b128 v[228:231], v11 offset:10240
    v_mfma_f32_16x16x32_bf16 v[192:195], a[16:19], v[252:255], v[192:195]
    ds_read_b128 v[232:235], v11 offset:12288
    v_and_b32 v39, 1, v0
    v_mfma_f32_16x16x32_bf16 v[196:199], a[20:23], v[252:255], v[196:199]
    buffer_load_dwordx4 v6, s[32:35], s60 offen offset:3072 lds
    v_lshl_add_u32 v38, v39, 7, v38
    v_mfma_f32_16x16x32_bf16 v[200:203], a[24:27], v[252:255], v[200:203]
    ds_read_b128 v[236:239], v11 offset:14336
    v_add_u32 v16, 81920, v38
    v_mfma_f32_16x16x32_bf16 v[204:207], a[28:31], v[252:255], v[204:207]
    s_waitcnt lgkmcnt(4)
    s_and_b32 s54, s2, 7
    s_lshl_b32 s62, s54, 2
    v_smfmac_f32_16x16x64_bf16 v[56:59], v[64:67], a[32:39], v13
    s_add_u32 m0, s59, 98304
    s_add_u32 s60, s97, s96
    s_bfe_u32 s54, s2, 0x20003
    v_smfmac_f32_16x16x64_bf16 v[60:63], v[64:67], a[40:47], v13
    s_waitcnt lgkmcnt(3)
    buffer_load_dwordx4 v3, s[32:35], s60 offen offset:0 lds
    s_add_u32 s62, s62, s54
    v_mfma_f32_16x16x32_bf16 v[144:147], a[32:35], v[224:227], v[144:147]
    s_lshr_b32 s63, s2, 5
    s_bfe_u32 s54, s2, 0x10001
    s_or_b32 s54, s54, 4
    v_mfma_f32_16x16x32_bf16 v[148:151], a[36:39], v[224:227], v[148:151]
    s_xor_b32 s63, s63, s54
    s_lshl_b32 s54, s3, 15
    s_lshl_b32 s55, s63, 7
    v_mfma_f32_16x16x32_bf16 v[152:155], a[40:43], v[224:227], v[152:155]
    buffer_load_dwordx4 v4, s[32:35], s60 offen offset:1024 lds
    s_add_u32 s64, s54, s55
    s_lshl_b32 s54, s62, 4
    v_mfma_f32_16x16x32_bf16 v[156:159], a[44:47], v[224:227], v[156:159]
    s_waitcnt lgkmcnt(0)
    s_waitcnt vmcnt(8)
    s_barrier
    v_mfma_f32_16x16x32_bf16 v[160:163], a[32:35], v[228:231], v[160:163]
    ds_read_b64_tr_b16 a[48:49], v9 offset:49152
    ds_read_b64_tr_b16 a[50:51], v9 offset:50176
    s_add_u32 s54, s54, s3
    v_mfma_f32_16x16x32_bf16 v[164:167], a[36:39], v[228:231], v[164:167]
    ds_read_b64_tr_b16 a[52:53], v10 offset:49152
    s_mul_i32 s66, s54, 14336
    s_mov_b32 s48, s22
    v_mfma_f32_16x16x32_bf16 v[168:171], a[40:43], v[228:231], v[168:171]
    buffer_load_dwordx4 v5, s[32:35], s60 offen offset:2048 lds
    s_mov_b32 s49, s23
    s_mov_b32 s50, 0x200000
    v_mfma_f32_16x16x32_bf16 v[172:175], a[44:47], v[228:231], v[172:175]
    ds_read_b64_tr_b16 a[54:55], v10 offset:50176
    ds_read_b64_tr_b16 a[56:57], v9 offset:57344
    s_mov_b32 s51, 0x20000
    v_mfma_f32_16x16x32_bf16 v[176:179], a[32:35], v[232:235], v[176:179]
    ds_read_b64_tr_b16 a[58:59], v9 offset:58368
    ds_read_b64_tr_b16 a[60:61], v10 offset:57344
    s_lshr_b32 s70, s63, 2
    v_mfma_f32_16x16x32_bf16 v[180:183], a[36:39], v[232:235], v[180:183]
    ds_read_b64_tr_b16 a[62:63], v10 offset:58368
    s_lshl_b32 s71, s70, 31
    s_xor_b32 s71, s71, 0xba000000
    v_mfma_f32_16x16x32_bf16 v[184:187], a[40:43], v[232:235], v[184:187]
    buffer_load_dwordx4 v6, s[32:35], s60 offen offset:3072 lds
    s_mul_i32 s54, s70, 7
    s_xor_b32 s69, s63, s54
    v_mfma_f32_16x16x32_bf16 v[188:191], a[44:47], v[232:235], v[188:191]
    ds_read_b128 v[240:243], v12 offset:8192
    ds_read_b128 v[244:247], v12 offset:10240
    s_lshl_b32 s69, s69, 5
    v_mfma_f32_16x16x32_bf16 v[192:195], a[32:35], v[236:239], v[192:195]
    s_add_u32 m0, s99, 40960
    s_xor_b32 s96, s72, 384
    s_add_u32 s75, s86, s96
    s_mul_i32 s96, s96, 1792
    ds_read_b128 v[248:251], v12 offset:12288
    v_mfma_f32_16x16x32_bf16 v[196:199], a[36:39], v[236:239], v[196:199]
    buffer_load_dwordx4 v1, s[28:31], s75 offen lds
    s_lshl_b32 s55, s70, 1
    s_sub_u32 s55, 1, s55
    v_mfma_f32_16x16x32_bf16 v[200:203], a[40:43], v[236:239], v[200:203]
    ds_read_b128 v[252:255], v12 offset:14336
    s_mul_i32 s54, s62, s55
    s_and_b32 s54, s54, 31
    v_mfma_f32_16x16x32_bf16 v[204:207], a[44:47], v[236:239], v[204:207]
    s_waitcnt lgkmcnt(4)
    s_lshl_b32 s54, s54, 16
    s_lshl_b32 s55, s3, 14
    v_smfmac_f32_16x16x64_bf16 v[56:59], v[64:67], a[48:55], v13
    s_add_u32 s54, s54, s55
    s_add_u32 s76, s54, 8388608
    s_add_u32 s77, s54, 8391680
    v_smfmac_f32_16x16x64_bf16 v[60:63], v[64:67], a[56:63], v13
    s_waitcnt lgkmcnt(3)
    buffer_load_dwordx4 v2, s[28:31], s75 offen offset:1024 lds
    s_add_u32 s78, s54, 8394752
    v_mfma_f32_16x16x32_bf16 v[144:147], a[48:51], v[240:243], v[144:147]
    s_cmp_lg_u32 s39, 1
    s_cbranch_scc1 NPF1
    buffer_load_dword v78, v78, s[44:47], 0 offen sc1
NPF1:
    v_mfma_f32_16x16x32_bf16 v[148:151], a[52:55], v[240:243], v[148:151]
    s_add_u32 m0, s59, 114688
    s_add_u32 s60, s98, s96
    s_add_u32 s79, s54, 8397824
    v_mfma_f32_16x16x32_bf16 v[152:155], a[56:59], v[240:243], v[152:155]
    buffer_load_dwordx4 v3, s[32:35], s60 offen offset:0 lds
    s_lshl_b32 s54, s3, 17
    s_lshl_b32 s55, s62, 10
    v_mfma_f32_16x16x32_bf16 v[156:159], a[60:63], v[240:243], v[156:159]
    s_waitcnt lgkmcnt(0)
    s_waitcnt vmcnt(7)
    s_barrier
    v_mfma_f32_16x16x32_bf16 v[160:163], a[48:51], v[244:247], v[160:163]
    ds_read_b64_tr_b16 a[64:65], v7 offset:0
    ds_read_b64_tr_b16 a[66:67], v7 offset:1024
    s_add_u32 s54, s54, s55
    v_mfma_f32_16x16x32_bf16 v[164:167], a[52:55], v[244:247], v[164:167]
    ds_read_b64_tr_b16 a[68:69], v8 offset:0
    s_lshl_b32 s55, s63, 7
    s_add_u32 s80, s54, s55
    v_mfma_f32_16x16x32_bf16 v[168:171], a[56:59], v[244:247], v[168:171]
    buffer_load_dwordx4 v4, s[32:35], s60 offen offset:1024 lds
    s_add_u32 s81, s80, 524288
    s_add_u32 s82, s80, 1048576
    v_mfma_f32_16x16x32_bf16 v[172:175], a[60:63], v[244:247], v[172:175]
    ds_read_b64_tr_b16 a[70:71], v8 offset:1024
    ds_read_b64_tr_b16 a[72:73], v7 offset:8192
    s_add_u32 s83, s80, 1572864
    v_mfma_f32_16x16x32_bf16 v[176:179], a[48:51], v[248:251], v[176:179]
    ds_read_b64_tr_b16 a[74:75], v7 offset:9216
    ds_read_b64_tr_b16 a[76:77], v8 offset:8192
    s_lshr_b32 s54, s62, 1
    v_mfma_f32_16x16x32_bf16 v[180:183], a[52:55], v[248:251], v[180:183]
    ds_read_b64_tr_b16 a[78:79], v8 offset:9216
    s_lshl_b32 s54, s54, 2
    s_add_u32 s54, s54, s3
    v_mfma_f32_16x16x32_bf16 v[184:187], a[56:59], v[248:251], v[184:187]
    buffer_load_dwordx4 v5, s[32:35], s60 offen offset:2048 lds
    s_mul_i32 s54, s54, 640
    s_add_u32 s53, s54, 12582912
    v_mfma_f32_16x16x32_bf16 v[188:191], a[60:63], v[248:251], v[188:191]
    ds_read_b128 v[224:227], v11 offset:16384
    ds_read_b128 v[228:231], v11 offset:18432
    s_lshl_b32 s54, s3, 9
    v_mfma_f32_16x16x32_bf16 v[192:195], a[48:51], v[252:255], v[192:195]
    ds_read_b128 v[232:235], v11 offset:20480
    s_lshl_b32 s55, s69, 2
    s_add_u32 s54, s54, s55
    v_mfma_f32_16x16x32_bf16 v[196:199], a[52:55], v[252:255], v[196:199]
    buffer_load_dwordx4 v6, s[32:35], s60 offen offset:3072 lds
    s_add_u32 s74, s54, 12623872
    s_min_u32 s55, s55, 128
    v_mfma_f32_16x16x32_bf16 v[200:203], a[56:59], v[252:255], v[200:203]
    ds_read_b128 v[236:239], v11 offset:22528
    s_lshl_b32 s54, s70, 7
    s_andn2_b32 s55, s55, s54
    v_mfma_f32_16x16x32_bf16 v[204:207], a[60:63], v[252:255], v[204:207]
    s_waitcnt lgkmcnt(4)
    s_sub_u32 s1, s74, s55
    v_lshrrev_b32 v38, 3, v0
    v_smfmac_f32_16x16x64_bf16 v[56:59], v[64:67], a[64:71], v13
    s_add_u32 m0, s59, 131072
    s_add_u32 s60, s97, s96
    v_and_b32 v39, 7, v0
    v_smfmac_f32_16x16x64_bf16 v[60:63], v[64:67], a[72:79], v13
    s_waitcnt lgkmcnt(3)
    buffer_load_dwordx4 v3, s[32:35], s60 offen offset:0 lds
    v_mfma_f32_16x16x32_bf16 v[144:147], a[64:67], v[224:227], v[144:147]
    v_and_b32 v24, 6, v38
    v_xor_b32 v39, v39, v24
    v_mfma_f32_16x16x32_bf16 v[148:151], a[68:71], v[224:227], v[148:151]
    buffer_load_dwordx4 v4, s[32:35], s60 offen offset:1024 lds
    v_lshlrev_b32 v39, 4, v39
    v_mfma_f32_16x16x32_bf16 v[152:155], a[72:75], v[224:227], v[152:155]
    v_lshl_add_u32 v24, v38, 10, v39
    v_add_u32 v25, 7168, v24
    v_mfma_f32_16x16x32_bf16 v[156:159], a[76:79], v[224:227], v[156:159]
    s_waitcnt lgkmcnt(0)
    s_waitcnt vmcnt(8)
    s_barrier
    v_mfma_f32_16x16x32_bf16 v[160:163], a[64:67], v[228:231], v[160:163]
    ds_read_b64_tr_b16 a[80:81], v9 offset:0
    ds_read_b64_tr_b16 a[82:83], v9 offset:1024
    v_mfma_f32_16x16x32_bf16 v[164:167], a[68:71], v[228:231], v[164:167]
    ds_read_b64_tr_b16 a[84:85], v10 offset:0
    v_add_u32 v26, 14336, v24
    v_mfma_f32_16x16x32_bf16 v[168:171], a[72:75], v[228:231], v[168:171]
    buffer_load_dwordx4 v5, s[32:35], s60 offen offset:2048 lds
    v_add_u32 v27, 21504, v24
    v_mfma_f32_16x16x32_bf16 v[172:175], a[76:79], v[228:231], v[172:175]
    ds_read_b64_tr_b16 a[86:87], v10 offset:1024
    ds_read_b64_tr_b16 a[88:89], v9 offset:8192
    v_mfma_f32_16x16x32_bf16 v[176:179], a[64:67], v[232:235], v[176:179]
    ds_read_b64_tr_b16 a[90:91], v9 offset:9216
    ds_read_b64_tr_b16 a[92:93], v10 offset:8192
    v_mfma_f32_16x16x32_bf16 v[180:183], a[68:71], v[232:235], v[180:183]
    ds_read_b64_tr_b16 a[94:95], v10 offset:9216
    v_lshrrev_b32 v39, 2, v0
    v_mfma_f32_16x16x32_bf16 v[184:187], a[72:75], v[232:235], v[184:187]
    buffer_load_dwordx4 v6, s[32:35], s60 offen offset:3072 lds
    v_lshlrev_b32 v28, 7, v39
    v_mfma_f32_16x16x32_bf16 v[188:191], a[76:79], v[232:235], v[188:191]
    ds_read_b128 v[240:243], v12 offset:16384
    ds_read_b128 v[244:247], v12 offset:18432
    v_mfma_f32_16x16x32_bf16 v[192:195], a[64:67], v[236:239], v[192:195]
    s_add_u32 m0, s99, 49152
    s_xor_b32 s96, s72, 512
    s_add_u32 s75, s86, s96
    s_mul_i32 s96, s96, 1792
    ds_read_b128 v[248:251], v12 offset:20480
    v_mfma_f32_16x16x32_bf16 v[196:199], a[68:71], v[236:239], v[196:199]
    buffer_load_dwordx4 v1, s[28:31], s75 offen lds
    v_bfe_u32 v39, v0, 3, 2
    v_mfma_f32_16x16x32_bf16 v[200:203], a[72:75], v[236:239], v[200:203]
    ds_read_b128 v[252:255], v12 offset:22528
    v_lshl_add_u32 v28, v39, 5, v28
    v_mfma_f32_16x16x32_bf16 v[204:207], a[76:79], v[236:239], v[204:207]
    s_waitcnt lgkmcnt(4)
    buffer_load_dwordx4 v2, s[28:31], s75 offen offset:1024 lds
    v_smfmac_f32_16x16x64_bf16 v[56:59], v[64:67], a[80:87], v13
    s_add_u32 m0, s59, 147456
    s_add_u32 s60, s98, s96
    v_and_b32 v39, 3, v0
    v_smfmac_f32_16x16x64_bf16 v[60:63], v[64:67], a[88:95], v13
    s_waitcnt lgkmcnt(3)
    buffer_load_dwordx4 v3, s[32:35], s60 offen offset:0 lds
    v_mfma_f32_16x16x32_bf16 v[144:147], a[80:83], v[240:243], v[144:147]
    v_lshl_add_u32 v28, v39, 3, v28
    v_add_u32 v28, s59, v28
    v_mfma_f32_16x16x32_bf16 v[148:151], a[84:87], v[240:243], v[148:151]
    buffer_load_dwordx4 v4, s[32:35], s60 offen offset:1024 lds
    v_xor_b32 v29, 32, v28
    v_mfma_f32_16x16x32_bf16 v[152:155], a[88:91], v[240:243], v[152:155]
    v_xor_b32 v30, 64, v28
    v_xor_b32 v31, 96, v28
    v_mfma_f32_16x16x32_bf16 v[156:159], a[92:95], v[240:243], v[156:159]
    s_waitcnt lgkmcnt(0)
    s_waitcnt vmcnt(8)
    s_barrier
    v_mfma_f32_16x16x32_bf16 v[160:163], a[80:83], v[244:247], v[160:163]
    ds_read_b64_tr_b16 a[96:97], v9 offset:16384
    ds_read_b64_tr_b16 a[98:99], v9 offset:17408
    v_mfma_f32_16x16x32_bf16 v[164:167], a[84:87], v[244:247], v[164:167]
    ds_read_b64_tr_b16 a[100:101], v10 offset:16384
    v_and_b32 v38, 7, v0
    v_mfma_f32_16x16x32_bf16 v[168:171], a[88:91], v[244:247], v[168:171]
    buffer_load_dwordx4 v5, s[32:35], s60 offen offset:2048 lds
    v_lshlrev_b32 v19, 4, v38
    v_mfma_f32_16x16x32_bf16 v[172:175], a[92:95], v[244:247], v[172:175]
    ds_read_b64_tr_b16 a[102:103], v10 offset:17408
    ds_read_b64_tr_b16 a[104:105], v9 offset:24576
    v_mfma_f32_16x16x32_bf16 v[176:179], a[80:83], v[248:251], v[176:179]
    ds_read_b64_tr_b16 a[106:107], v9 offset:25600
    ds_read_b64_tr_b16 a[108:109], v10 offset:24576
    v_mfma_f32_16x16x32_bf16 v[180:183], a[84:87], v[248:251], v[180:183]
    ds_read_b64_tr_b16 a[110:111], v10 offset:25600
    v_bfe_u32 v38, v0, 3, 2
    v_mfma_f32_16x16x32_bf16 v[184:187], a[88:91], v[248:251], v[184:187]
    buffer_load_dwordx4 v6, s[32:35], s60 offen offset:3072 lds
    v_lshl_add_u32 v19, v38, 15, v19
    v_mfma_f32_16x16x32_bf16 v[188:191], a[92:95], v[248:251], v[188:191]
    ds_read_b128 v[224:227], v11 offset:24576
    ds_read_b128 v[228:231], v11 offset:26624
    v_mfma_f32_16x16x32_bf16 v[192:195], a[80:83], v[252:255], v[192:195]
    s_add_u32 m0, s59, 0
    s_add_u32 s60, s97, s96
    ds_read_b128 v[232:235], v11 offset:28672
    v_mfma_f32_16x16x32_bf16 v[196:199], a[84:87], v[252:255], v[196:199]
    buffer_load_dwordx4 v3, s[32:35], s60 offen offset:0 lds
    v_lshrrev_b32 v38, 5, v0
    v_mfma_f32_16x16x32_bf16 v[200:203], a[88:91], v[252:255], v[200:203]
    ds_read_b128 v[236:239], v11 offset:30720
    ds_read_u8 v21, v0
    v_lshl_add_u32 v19, v38, 19, v19
    v_mfma_f32_16x16x32_bf16 v[204:207], a[92:95], v[252:255], v[204:207]
    s_waitcnt lgkmcnt(4)
    buffer_load_dwordx4 v4, s[32:35], s60 offen offset:1024 lds
    s_lshl_b32 s54, s3, 11
    v_smfmac_f32_16x16x64_bf16 v[56:59], v[64:67], a[96:103], v13
    s_add_u32 s54, s54, 86016
    v_lshl_add_u32 v20, v0, 3, s54
    v_and_b32 v38, 15, v0
    v_smfmac_f32_16x16x64_bf16 v[60:63], v[64:67], a[104:111], v13
    s_waitcnt lgkmcnt(3)
    buffer_load_dwordx4 v5, s[32:35], s60 offen offset:2048 lds
    v_mfma_f32_16x16x32_bf16 v[144:147], a[96:99], v[224:227], v[144:147]
    s_mov_b32 s57, 0
    s_load_dword s57, s[24:25], 0
    v_lshlrev_b32 v17, 4, v0
    v_mfma_f32_16x16x32_bf16 v[148:151], a[100:103], v[224:227], v[148:151]
    buffer_load_dwordx4 v6, s[32:35], s60 offen offset:3072 lds
    v_lshrrev_b32 v76, 4, v0
    v_mfma_f32_16x16x32_bf16 v[152:155], a[104:107], v[224:227], v[152:155]
    v_lshrrev_b32 v32, 5, v0
    s_xor_b32 s54, s70, 1
    v_mfma_f32_16x16x32_bf16 v[156:159], a[108:111], v[224:227], v[156:159]
    s_waitcnt lgkmcnt(1)
    s_waitcnt vmcnt(10)
    s_barrier
    v_mfma_f32_16x16x32_bf16 v[160:163], a[96:99], v[228:231], v[160:163]
    ds_read_b64_tr_b16 a[112:113], v9 offset:32768
    ds_read_b64_tr_b16 a[114:115], v9 offset:33792
    v_mfma_f32_16x16x32_bf16 v[164:167], a[100:103], v[228:231], v[164:167]
    s_add_u32 m0, s99, 57344
    s_xor_b32 s96, s72, 640
    s_add_u32 s75, s86, s96
    s_mul_i32 s96, s96, 1792
    ds_read_b64_tr_b16 a[116:117], v10 offset:32768
    v_mfma_f32_16x16x32_bf16 v[168:171], a[104:107], v[228:231], v[168:171]
    buffer_load_dwordx4 v1, s[28:31], s75 offen lds
    v_and_b32 v39, s54, v32
    v_mfma_f32_16x16x32_bf16 v[172:175], a[108:111], v[228:231], v[172:175]
    ds_read_b64_tr_b16 a[118:119], v10 offset:33792
    ds_read_b64_tr_b16 a[120:121], v9 offset:40960
    v_mfma_f32_16x16x32_bf16 v[176:179], a[96:99], v[232:235], v[176:179]
    ds_read_b64_tr_b16 a[122:123], v9 offset:41984
    ds_read_b64_tr_b16 a[124:125], v10 offset:40960
    v_mfma_f32_16x16x32_bf16 v[180:183], a[100:103], v[232:235], v[180:183]
    ds_read_b64_tr_b16 a[126:127], v10 offset:41984
    v_sub_u32 v39, s69, v39
    v_mfma_f32_16x16x32_bf16 v[184:187], a[104:107], v[232:235], v[184:187]
    buffer_load_dwordx4 v2, s[28:31], s75 offen offset:1024 lds
    v_and_b32 v33, 31, v0
    v_mfma_f32_16x16x32_bf16 v[188:191], a[108:111], v[232:235], v[188:191]
    ds_read_b128 v[240:243], v12 offset:24576
    ds_read_b128 v[244:247], v12 offset:26624
    v_mfma_f32_16x16x32_bf16 v[192:195], a[96:99], v[236:239], v[192:195]
    s_add_u32 m0, s59, 98304
    s_add_u32 s60, s98, s96
    ds_read_b128 v[248:251], v12 offset:28672
    v_mfma_f32_16x16x32_bf16 v[196:199], a[100:103], v[236:239], v[196:199]
    buffer_load_dwordx4 v3, s[32:35], s60 offen offset:0 lds
    v_add_u32 v39, v39, v33
    v_mfma_f32_16x16x32_bf16 v[200:203], a[104:107], v[236:239], v[200:203]
    ds_read_b128 v[252:255], v12 offset:30720
    ds_read_u8 v21, v0
    v_bfe_u32 v39, v39, 0, 26
    v_mfma_f32_16x16x32_bf16 v[204:207], a[108:111], v[236:239], v[204:207]
    s_waitcnt lgkmcnt(4)
    buffer_load_dwordx4 v4, s[32:35], s60 offen offset:1024 lds
    v_smfmac_f32_16x16x64_bf16 v[56:59], v[64:67], a[112:119], v13
    v_lshlrev_b32 v32, 11, v32
    v_lshl_add_u32 v32, v39, 4, v32
    v_smfmac_f32_16x16x64_bf16 v[60:63], v[64:67], a[120:127], v13
    s_waitcnt lgkmcnt(3)
    buffer_load_dwordx4 v5, s[32:35], s60 offen offset:2048 lds
    s_mul_i32 s54, s70, 31
    v_mfma_f32_16x16x32_bf16 v[144:147], a[112:115], v[240:243], v[144:147]
    s_or_b32 s54, s54, 32
    v_lshrrev_b32 v39, 1, v38
    v_and_b32 v33, 1, v0
    v_mfma_f32_16x16x32_bf16 v[148:151], a[116:119], v[240:243], v[148:151]
    buffer_load_dwordx4 v6, s[32:35], s60 offen offset:3072 lds
    v_lshl_add_u32 v39, v33, 5, v39
    v_mfma_f32_16x16x32_bf16 v[152:155], a[120:123], v[240:243], v[152:155]
    v_xor_b32 v39, s54, v39
    v_lshlrev_b32 v39, 4, v39
    v_mfma_f32_16x16x32_bf16 v[156:159], a[124:127], v[240:243], v[156:159]
    s_waitcnt lgkmcnt(1)
    s_waitcnt vmcnt(10)
    s_barrier
    v_mfma_f32_16x16x32_bf16 v[160:163], a[112:115], v[244:247], v[160:163]
    ds_read_b64_tr_b16 a[128:129], v9 offset:49152
    ds_read_b64_tr_b16 a[130:131], v9 offset:50176
    v_mfma_f32_16x16x32_bf16 v[164:167], a[116:119], v[244:247], v[164:167]
    s_add_u32 m0, s59, 114688
    s_add_u32 s60, s97, s96
    ds_read_b64_tr_b16 a[132:133], v10 offset:49152
    v_mfma_f32_16x16x32_bf16 v[168:171], a[120:123], v[244:247], v[168:171]
    buffer_load_dwordx4 v3, s[32:35], s60 offen offset:0 lds
    v_lshl_add_u32 v39, v76, 10, v39
    v_mfma_f32_16x16x32_bf16 v[172:175], a[124:127], v[244:247], v[172:175]
    ds_read_b64_tr_b16 a[134:135], v10 offset:50176
    ds_read_b64_tr_b16 a[136:137], v9 offset:57344
    v_mfma_f32_16x16x32_bf16 v[176:179], a[112:115], v[248:251], v[176:179]
    ds_read_b64_tr_b16 a[138:139], v9 offset:58368
    ds_read_b64_tr_b16 a[140:141], v10 offset:57344
    v_mfma_f32_16x16x32_bf16 v[180:183], a[116:119], v[248:251], v[180:183]
    ds_read_b64_tr_b16 a[142:143], v10 offset:58368
    v_add_u32 v33, s59, v39
    v_mfma_f32_16x16x32_bf16 v[184:187], a[120:123], v[248:251], v[184:187]
    buffer_load_dwordx4 v4, s[32:35], s60 offen offset:1024 lds
    v_lshlrev_b32 v39, 3, v38
    v_mfma_f32_16x16x32_bf16 v[188:191], a[124:127], v[248:251], v[188:191]
    ds_read_b128 v[224:227], v11 offset:32768
    ds_read_b128 v[228:231], v11 offset:34816
    v_mfma_f32_16x16x32_bf16 v[192:195], a[112:115], v[252:255], v[192:195]
    ds_read_b128 v[232:235], v11 offset:36864
    v_lshl_add_u32 v37, v76, 15, v39
    v_mfma_f32_16x16x32_bf16 v[196:199], a[116:119], v[252:255], v[196:199]
    buffer_load_dwordx4 v5, s[32:35], s60 offen offset:2048 lds
    v_and_b32 v39, 7, v0
    v_mfma_f32_16x16x32_bf16 v[200:203], a[120:123], v[252:255], v[200:203]
    ds_read_b128 v[236:239], v11 offset:38912
    ds_read_u8 v21, v0
    v_xor_b32 v39, v39, v76
    v_mfma_f32_16x16x32_bf16 v[204:207], a[124:127], v[252:255], v[204:207]
    s_waitcnt lgkmcnt(4)
    buffer_load_dwordx4 v6, s[32:35], s60 offen offset:3072 lds
    v_smfmac_f32_16x16x64_bf16 v[56:59], v[64:67], a[128:135], v13
    s_add_u32 m0, s99, 65536
    s_xor_b32 s96, s72, 768
    s_add_u32 s75, s86, s96
    s_mul_i32 s96, s96, 1792
    v_smfmac_f32_16x16x64_bf16 v[60:63], v[64:67], a[136:143], v13
    s_waitcnt lgkmcnt(3)
    buffer_load_dwordx4 v1, s[28:31], s75 offen lds
    v_mfma_f32_16x16x32_bf16 v[144:147], a[128:131], v[224:227], v[144:147]
    v_lshlrev_b32 v39, 4, v39
    v_lshl_add_u32 v39, v38, 8, v39
    v_mfma_f32_16x16x32_bf16 v[148:151], a[132:135], v[224:227], v[148:151]
    v_add_u32 v39, 98304, v39
    v_add_u32 v34, s59, v39
    v_mfma_f32_16x16x32_bf16 v[152:155], a[136:139], v[224:227], v[152:155]
    buffer_load_dwordx4 v2, s[28:31], s75 offen offset:1024 lds
    v_xor_b32 v35, 64, v34
    v_mfma_f32_16x16x32_bf16 v[156:159], a[140:143], v[224:227], v[156:159]
    s_waitcnt lgkmcnt(1)
    s_waitcnt vmcnt(12)
    s_barrier
    v_mfma_f32_16x16x32_bf16 v[160:163], a[128:131], v[228:231], v[160:163]
    ds_read_b64_tr_b16 a[144:145], v7 offset:0
    ds_read_b64_tr_b16 a[146:147], v7 offset:1024
    v_mfma_f32_16x16x32_bf16 v[164:167], a[132:135], v[228:231], v[164:167]
    s_add_u32 m0, s59, 131072
    s_add_u32 s60, s98, s96
    ds_read_b64_tr_b16 a[148:149], v8 offset:0
    v_mfma_f32_16x16x32_bf16 v[168:171], a[136:139], v[228:231], v[168:171]
    buffer_load_dwordx4 v3, s[32:35], s60 offen offset:0 lds
    v_lshl_add_u32 v39, s3, 2, v76
    v_mfma_f32_16x16x32_bf16 v[172:175], a[140:143], v[228:231], v[172:175]
    ds_read_b64_tr_b16 a[150:151], v8 offset:1024
    ds_read_b64_tr_b16 a[152:153], v7 offset:8192
    v_mfma_f32_16x16x32_bf16 v[176:179], a[128:131], v[232:235], v[176:179]
    ds_read_b64_tr_b16 a[154:155], v7 offset:9216
    ds_read_b64_tr_b16 a[156:157], v8 offset:8192
    v_mfma_f32_16x16x32_bf16 v[180:183], a[132:135], v[232:235], v[180:183]
    ds_read_b64_tr_b16 a[158:159], v8 offset:9216
    v_and_b32 v36, 7, v39
    v_mfma_f32_16x16x32_bf16 v[184:187], a[136:139], v[232:235], v[184:187]
    buffer_load_dwordx4 v4, s[32:35], s60 offen offset:1024 lds
    v_xor_b32 v36, v36, v38
    v_mfma_f32_16x16x32_bf16 v[188:191], a[140:143], v[232:235], v[188:191]
    ds_read_b128 v[240:243], v12 offset:32768
    ds_read_b128 v[244:247], v12 offset:34816
    v_mfma_f32_16x16x32_bf16 v[192:195], a[128:131], v[236:239], v[192:195]
    ds_read_b128 v[248:251], v12 offset:36864
    v_lshlrev_b32 v36, 4, v36
    v_mfma_f32_16x16x32_bf16 v[196:199], a[132:135], v[236:239], v[196:199]
    buffer_load_dwordx4 v5, s[32:35], s60 offen offset:2048 lds
    v_lshl_add_u32 v36, v39, 8, v36
    v_mfma_f32_16x16x32_bf16 v[200:203], a[136:139], v[236:239], v[200:203]
    ds_read_b128 v[252:255], v12 offset:38912
    ds_read_u8 v21, v0
    v_add_u32 v36, 98304, v36
    v_mfma_f32_16x16x32_bf16 v[204:207], a[140:143], v[236:239], v[204:207]
HG1:
    s_cbranch_execz HBG
    s_waitcnt lgkmcnt(4)
    v_lshl_add_u32 v38, v38, 5, s62
    v_cvt_f32_u32 v38, v38
    v_smfmac_f32_16x16x64_bf16 v[56:59], v[64:67], a[144:151], v13
    v_lshlrev_b32 v39, 2, v39
    v_cvt_f32_u32 v39, v39
    v_smfmac_f32_16x16x64_bf16 v[60:63], v[64:67], a[152:159], v13
    s_waitcnt lgkmcnt(3)
    buffer_load_dwordx4 v6, s[32:35], s60 offen offset:3072 lds
    s_and_b32 s54, s63, 1
    v_mfma_f32_16x16x32_bf16 v[144:147], a[144:147], v[240:243], v[144:147]
    s_cmp_lg_u32 s39, 2
    s_cbranch_scc1 NPF2
    buffer_load_dword v78, v78, s[44:47], 0 offen sc1
NPF2:
    v_mfma_f32_16x16x32_bf16 v[148:151], a[148:151], v[240:243], v[148:151]
    s_add_u32 m0, s59, 147456
    s_add_u32 s60, s97, s96
    s_mul_i32 s55, s54, 917504
    v_mfma_f32_16x16x32_bf16 v[152:155], a[152:155], v[240:243], v[152:155]
    buffer_load_dwordx4 v3, s[32:35], s60 offen offset:0 lds
    s_mul_i32 s54, s54, 7168
    s_sub_u32 s62, s64, s55
    v_mfma_f32_16x16x32_bf16 v[156:159], a[156:159], v[240:243], v[156:159]
    s_waitcnt lgkmcnt(1)
    s_waitcnt vmcnt(11)
    s_barrier
    v_mfma_f32_16x16x32_bf16 v[160:163], a[144:147], v[244:247], v[160:163]
    ds_read_b64_tr_b16 a[160:161], v9 offset:0
    ds_read_b64_tr_b16 a[162:163], v9 offset:1024
    s_add_u32 s64, s64, s55
    v_mfma_f32_16x16x32_bf16 v[164:167], a[148:151], v[244:247], v[164:167]
    ds_read_b64_tr_b16 a[164:165], v10 offset:0
    s_sub_u32 s63, s66, s54
    s_add_u32 s66, s66, s54
    v_mfma_f32_16x16x32_bf16 v[168:171], a[152:155], v[244:247], v[168:171]
    buffer_load_dwordx4 v4, s[32:35], s60 offen offset:1024 lds
    v_mfma_f32_16x16x32_bf16 v[172:175], a[156:159], v[244:247], v[172:175]
    ds_read_b64_tr_b16 a[166:167], v10 offset:1024
    ds_read_b64_tr_b16 a[168:169], v9 offset:8192
    v_mfma_f32_16x16x32_bf16 v[176:179], a[144:147], v[248:251], v[176:179]
    ds_read_b64_tr_b16 a[170:171], v9 offset:9216
    ds_read_b64_tr_b16 a[172:173], v10 offset:8192
    v_mfma_f32_16x16x32_bf16 v[180:183], a[148:151], v[248:251], v[180:183]
    ds_read_b64_tr_b16 a[174:175], v10 offset:9216
    v_mfma_f32_16x16x32_bf16 v[184:187], a[152:155], v[248:251], v[184:187]
    buffer_load_dwordx4 v5, s[32:35], s60 offen offset:2048 lds
    v_mfma_f32_16x16x32_bf16 v[188:191], a[156:159], v[248:251], v[188:191]
    ds_read_b128 v[224:227], v11 offset:40960
    ds_read_b128 v[228:231], v11 offset:43008
    v_mfma_f32_16x16x32_bf16 v[192:195], a[144:147], v[252:255], v[192:195]
    ds_read_b128 v[232:235], v11 offset:45056
    v_mfma_f32_16x16x32_bf16 v[196:199], a[148:151], v[252:255], v[196:199]
    buffer_load_dwordx4 v6, s[32:35], s60 offen offset:3072 lds
    v_mfma_f32_16x16x32_bf16 v[200:203], a[152:155], v[252:255], v[200:203]
    ds_read_b128 v[236:239], v11 offset:47104
    v_mfma_f32_16x16x32_bf16 v[204:207], a[156:159], v[252:255], v[204:207]
    s_waitcnt lgkmcnt(4)
    v_smfmac_f32_16x16x64_bf16 v[56:59], v[64:67], a[160:167], v13
    s_add_u32 m0, s99, 73728
    s_xor_b32 s96, s72, 896
    s_add_u32 s75, s86, s96
    s_mul_i32 s96, s96, 1792
    v_smfmac_f32_16x16x64_bf16 v[60:63], v[64:67], a[168:175], v13
    s_waitcnt lgkmcnt(3)
    buffer_load_dwordx4 v1, s[28:31], s75 offen lds
    v_mfma_f32_16x16x32_bf16 v[144:147], a[160:163], v[224:227], v[144:147]
    v_mfma_f32_16x16x32_bf16 v[148:151], a[164:167], v[224:227], v[148:151]
    v_mfma_f32_16x16x32_bf16 v[152:155], a[168:171], v[224:227], v[152:155]
    buffer_load_dwordx4 v2, s[28:31], s75 offen offset:1024 lds
    v_mfma_f32_16x16x32_bf16 v[156:159], a[172:175], v[224:227], v[156:159]
    s_waitcnt lgkmcnt(0)
    s_waitcnt vmcnt(12)
    s_barrier
    v_mfma_f32_16x16x32_bf16 v[160:163], a[160:163], v[228:231], v[160:163]
    ds_read_b64_tr_b16 a[176:177], v9 offset:16384
    ds_read_b64_tr_b16 a[178:179], v9 offset:17408
    v_mfma_f32_16x16x32_bf16 v[164:167], a[164:167], v[228:231], v[164:167]
    s_add_u32 m0, s59, 0
    s_add_u32 s60, s98, s96
    ds_read_b64_tr_b16 a[180:181], v10 offset:16384
    v_mfma_f32_16x16x32_bf16 v[168:171], a[168:171], v[228:231], v[168:171]
    buffer_load_dwordx4 v3, s[32:35], s60 offen offset:0 lds
    v_mfma_f32_16x16x32_bf16 v[172:175], a[172:175], v[228:231], v[172:175]
    ds_read_b64_tr_b16 a[182:183], v10 offset:17408
    ds_read_b64_tr_b16 a[184:185], v9 offset:24576
    v_mfma_f32_16x16x32_bf16 v[176:179], a[160:163], v[232:235], v[176:179]
    ds_read_b64_tr_b16 a[186:187], v9 offset:25600
    ds_read_b64_tr_b16 a[188:189], v10 offset:24576
    v_mfma_f32_16x16x32_bf16 v[180:183], a[164:167], v[232:235], v[180:183]
    ds_read_b64_tr_b16 a[190:191], v10 offset:25600
    v_mfma_f32_16x16x32_bf16 v[184:187], a[168:171], v[232:235], v[184:187]
    buffer_load_dwordx4 v4, s[32:35], s60 offen offset:1024 lds
    v_mfma_f32_16x16x32_bf16 v[188:191], a[172:175], v[232:235], v[188:191]
    ds_read_b128 v[240:243], v12 offset:40960
    ds_read_b128 v[244:247], v12 offset:43008
    v_mfma_f32_16x16x32_bf16 v[192:195], a[160:163], v[236:239], v[192:195]
    ds_read_b128 v[248:251], v12 offset:45056
    v_mfma_f32_16x16x32_bf16 v[196:199], a[164:167], v[236:239], v[196:199]
    buffer_load_dwordx4 v5, s[32:35], s60 offen offset:2048 lds
    v_mfma_f32_16x16x32_bf16 v[200:203], a[168:171], v[236:239], v[200:203]
    ds_read_b128 v[252:255], v12 offset:47104
    v_mfma_f32_16x16x32_bf16 v[204:207], a[172:175], v[236:239], v[204:207]
    s_waitcnt lgkmcnt(4)
    v_smfmac_f32_16x16x64_bf16 v[56:59], v[64:67], a[176:183], v13
    v_smfmac_f32_16x16x64_bf16 v[60:63], v[64:67], a[184:191], v13
    s_waitcnt lgkmcnt(3)
    buffer_load_dwordx4 v6, s[32:35], s60 offen offset:3072 lds
    v_mfma_f32_16x16x32_bf16 v[144:147], a[176:179], v[240:243], v[144:147]
    s_cmp_lg_u32 s39, 3
    s_cbranch_scc1 NPF3
    buffer_load_dword v78, v78, s[44:47], 0 offen sc1
NPF3:
    v_mfma_f32_16x16x32_bf16 v[148:151], a[180:183], v[240:243], v[148:151]
    s_add_u32 m0, s59, 98304
    s_add_u32 s60, s97, s96
    v_mfma_f32_16x16x32_bf16 v[152:155], a[184:187], v[240:243], v[152:155]
    buffer_load_dwordx4 v3, s[32:35], s60 offen offset:0 lds
    v_mfma_f32_16x16x32_bf16 v[156:159], a[188:191], v[240:243], v[156:159]
    s_waitcnt lgkmcnt(0)
    s_waitcnt vmcnt(11)
    s_barrier
    v_mfma_f32_16x16x32_bf16 v[160:163], a[176:179], v[244:247], v[160:163]
    ds_read_b64_tr_b16 a[192:193], v9 offset:32768
    ds_read_b64_tr_b16 a[194:195], v9 offset:33792
    v_mfma_f32_16x16x32_bf16 v[164:167], a[180:183], v[244:247], v[164:167]
    ds_read_b64_tr_b16 a[196:197], v10 offset:32768
    v_mfma_f32_16x16x32_bf16 v[168:171], a[184:187], v[244:247], v[168:171]
    buffer_load_dwordx4 v4, s[32:35], s60 offen offset:1024 lds
    v_mfma_f32_16x16x32_bf16 v[172:175], a[188:191], v[244:247], v[172:175]
    ds_read_b64_tr_b16 a[198:199], v10 offset:33792
    ds_read_b64_tr_b16 a[200:201], v9 offset:40960
    v_mfma_f32_16x16x32_bf16 v[176:179], a[176:179], v[248:251], v[176:179]
    ds_read_b64_tr_b16 a[202:203], v9 offset:41984
    ds_read_b64_tr_b16 a[204:205], v10 offset:40960
    v_mfma_f32_16x16x32_bf16 v[180:183], a[180:183], v[248:251], v[180:183]
    ds_read_b64_tr_b16 a[206:207], v10 offset:41984
    v_mfma_f32_16x16x32_bf16 v[184:187], a[184:187], v[248:251], v[184:187]
    buffer_load_dwordx4 v5, s[32:35], s60 offen offset:2048 lds
    v_mfma_f32_16x16x32_bf16 v[188:191], a[188:191], v[248:251], v[188:191]
    ds_read_b128 v[224:227], v11 offset:49152
    ds_read_b128 v[228:231], v11 offset:51200
    v_mfma_f32_16x16x32_bf16 v[192:195], a[176:179], v[252:255], v[192:195]
    ds_read_b128 v[232:235], v11 offset:53248
    v_mfma_f32_16x16x32_bf16 v[196:199], a[180:183], v[252:255], v[196:199]
    buffer_load_dwordx4 v6, s[32:35], s60 offen offset:3072 lds
    v_mfma_f32_16x16x32_bf16 v[200:203], a[184:187], v[252:255], v[200:203]
    ds_read_b128 v[236:239], v11 offset:55296
    ds_read_u8 v21, v0
    v_mfma_f32_16x16x32_bf16 v[204:207], a[188:191], v[252:255], v[204:207]
    s_waitcnt lgkmcnt(4)
    v_smfmac_f32_16x16x64_bf16 v[56:59], v[64:67], a[192:199], v13
    s_add_u32 m0, s59, 16384
    s_add_u32 s75, s84, 1048576
    v_smfmac_f32_16x16x64_bf16 v[60:63], v[64:67], a[200:207], v13
    s_waitcnt lgkmcnt(3)
    buffer_load_dwordx4 v1, s[28:31], s75 offen lds
    v_mfma_f32_16x16x32_bf16 v[144:147], a[192:195], v[224:227], v[144:147]
    s_cmp_ge_u32 s57, 32
    s_cbranch_scc0 SL_clr
BK_clr:
    s_mov_b32 s57, 0
    s_load_dword s57, s[26:27], s38
    v_mfma_f32_16x16x32_bf16 v[148:151], a[196:199], v[224:227], v[148:151]
    v_mfma_f32_16x16x32_bf16 v[152:155], a[200:203], v[224:227], v[152:155]
    buffer_load_dwordx4 v2, s[28:31], s75 offen offset:1024 lds
    v_mfma_f32_16x16x32_bf16 v[156:159], a[204:207], v[224:227], v[156:159]
    s_waitcnt lgkmcnt(1)
    s_waitcnt vmcnt(12)
    s_barrier
    v_mfma_f32_16x16x32_bf16 v[160:163], a[192:195], v[228:231], v[160:163]
    ds_read_b64_tr_b16 a[208:209], v9 offset:49152
    ds_read_b64_tr_b16 a[210:211], v9 offset:50176
    v_mfma_f32_16x16x32_bf16 v[164:167], a[196:199], v[228:231], v[164:167]
    s_add_u32 m0, s59, 18432
    s_add_u32 s75, s85, 1048576
    ds_read_b64_tr_b16 a[212:213], v10 offset:49152
    v_mfma_f32_16x16x32_bf16 v[168:171], a[200:203], v[228:231], v[168:171]
    buffer_load_dwordx4 v1, s[28:31], s75 offen lds
    v_mfma_f32_16x16x32_bf16 v[172:175], a[204:207], v[228:231], v[172:175]
    ds_read_b64_tr_b16 a[214:215], v10 offset:50176
    ds_read_b64_tr_b16 a[216:217], v9 offset:57344
    v_mfma_f32_16x16x32_bf16 v[176:179], a[192:195], v[232:235], v[176:179]
    ds_read_b64_tr_b16 a[218:219], v9 offset:58368
    ds_read_b64_tr_b16 a[220:221], v10 offset:57344
    v_mfma_f32_16x16x32_bf16 v[180:183], a[196:199], v[232:235], v[180:183]
    ds_read_b64_tr_b16 a[222:223], v10 offset:58368
    v_mfma_f32_16x16x32_bf16 v[184:187], a[200:203], v[232:235], v[184:187]
    buffer_load_dwordx4 v2, s[28:31], s75 offen offset:1024 lds
    v_mfma_f32_16x16x32_bf16 v[188:191], a[204:207], v[232:235], v[188:191]
    ds_read_b128 v[240:243], v12 offset:49152
    ds_read_b128 v[244:247], v12 offset:51200
    v_mfma_f32_16x16x32_bf16 v[192:195], a[192:195], v[236:239], v[192:195]
    s_add_u32 m0, s59, 32768
    s_add_u32 s75, s84, 1049600
    ds_read_b128 v[248:251], v12 offset:53248
    v_mfma_f32_16x16x32_bf16 v[196:199], a[196:199], v[236:239], v[196:199]
    buffer_load_dwordx4 v1, s[28:31], s75 offen lds
    v_mfma_f32_16x16x32_bf16 v[200:203], a[200:203], v[236:239], v[200:203]
    ds_read_b128 v[252:255], v12 offset:55296
    ds_read_u8 v21, v0
    v_mfma_f32_16x16x32_bf16 v[204:207], a[204:207], v[236:239], v[204:207]
    s_waitcnt lgkmcnt(4)
    v_smfmac_f32_16x16x64_bf16 v[56:59], v[64:67], a[208:215], v13
    v_smfmac_f32_16x16x64_bf16 v[60:63], v[64:67], a[216:223], v13
    s_waitcnt lgkmcnt(3)
    buffer_load_dwordx4 v2, s[28:31], s75 offen offset:1024 lds
    v_mfma_f32_16x16x32_bf16 v[144:147], a[208:211], v[240:243], v[144:147]
    v_mfma_f32_16x16x32_bf16 v[148:151], a[212:215], v[240:243], v[148:151]
    s_add_u32 m0, s59, 34816
    s_add_u32 s75, s85, 1049600
    v_mfma_f32_16x16x32_bf16 v[152:155], a[216:219], v[240:243], v[152:155]
    buffer_load_dwordx4 v1, s[28:31], s75 offen lds
    v_mfma_f32_16x16x32_bf16 v[156:159], a[220:223], v[240:243], v[156:159]
    s_waitcnt lgkmcnt(1)
    s_waitcnt vmcnt(11)
    s_barrier
    v_mfma_f32_16x16x32_bf16 v[160:163], a[208:211], v[244:247], v[160:163]
    ds_read_b64_tr_b16 a[224:225], v7 offset:0
    ds_read_b64_tr_b16 a[226:227], v7 offset:1024
    v_mfma_f32_16x16x32_bf16 v[164:167], a[212:215], v[244:247], v[164:167]
    ds_read_b64_tr_b16 a[228:229], v8 offset:0
    v_mfma_f32_16x16x32_bf16 v[168:171], a[216:219], v[244:247], v[168:171]
    buffer_load_dwordx4 v2, s[28:31], s75 offen offset:1024 lds
    v_mfma_f32_16x16x32_bf16 v[172:175], a[220:223], v[244:247], v[172:175]
    ds_read_b64_tr_b16 a[230:231], v8 offset:1024
    ds_read_b64_tr_b16 a[232:233], v7 offset:8192
    v_mfma_f32_16x16x32_bf16 v[176:179], a[208:211], v[248:251], v[176:179]
    ds_read_b64_tr_b16 a[234:235], v7 offset:9216
    ds_read_b64_tr_b16 a[236:237], v8 offset:8192
    v_mfma_f32_16x16x32_bf16 v[180:183], a[212:215], v[248:251], v[180:183]
    s_cmp_ge_u32 s57, 8
    s_cbranch_scc0 SL_s0
BK_s0:
    s_mov_b32 m0, s37
    s_nop 0
    buffer_load_dword v15, s[40:43], s36 offen offset:0 sc1 lds
    buffer_load_dword v15, s[40:43], s36 offen offset:1024 sc1 lds
    s_add_u32 m0, s59, 49152
    s_add_u32 s75, s84, 1572864
    ds_read_b64_tr_b16 a[238:239], v8 offset:9216
    v_mfma_f32_16x16x32_bf16 v[184:187], a[216:219], v[248:251], v[184:187]
    buffer_load_dwordx4 v1, s[28:31], s75 offen lds
    v_mfma_f32_16x16x32_bf16 v[188:191], a[220:223], v[248:251], v[188:191]
    ds_read_b128 v[224:227], v11 offset:57344
    ds_read_b128 v[228:231], v11 offset:59392
    v_mfma_f32_16x16x32_bf16 v[192:195], a[208:211], v[252:255], v[192:195]
    ds_read_b128 v[232:235], v11 offset:61440
    v_mfma_f32_16x16x32_bf16 v[196:199], a[212:215], v[252:255], v[196:199]
    buffer_load_dwordx4 v2, s[28:31], s75 offen offset:1024 lds
    v_mfma_f32_16x16x32_bf16 v[200:203], a[216:219], v[252:255], v[200:203]
    ds_read_b128 v[236:239], v11 offset:63488
    ds_read_u8 v21, v0
    v_mfma_f32_16x16x32_bf16 v[204:207], a[220:223], v[252:255], v[204:207]
    s_waitcnt lgkmcnt(4)
    v_smfmac_f32_16x16x64_bf16 v[56:59], v[64:67], a[224:231], v13
    s_add_u32 m0, s59, 51200
    s_add_u32 s75, s85, 1572864
    v_smfmac_f32_16x16x64_bf16 v[60:63], v[64:67], a[232:239], v13
    s_waitcnt lgkmcnt(3)
    buffer_load_dwordx4 v1, s[28:31], s75 offen lds
    v_mfma_f32_16x16x32_bf16 v[144:147], a[224:227], v[224:227], v[144:147]
    buffer_load_dword v77, v77, s[44:47], 0 offen sc1
    v_mfma_f32_16x16x32_bf16 v[148:151], a[228:231], v[224:227], v[148:151]
    v_mfma_f32_16x16x32_bf16 v[152:155], a[232:235], v[224:227], v[152:155]
    buffer_load_dwordx4 v2, s[28:31], s75 offen offset:1024 lds
    v_mfma_f32_16x16x32_bf16 v[156:159], a[236:239], v[224:227], v[156:159]
    s_waitcnt lgkmcnt(1)
    s_waitcnt vmcnt(15)
    s_barrier
    v_mfma_f32_16x16x32_bf16 v[160:163], a[224:227], v[228:231], v[160:163]
    ds_read_b64_tr_b16 a[240:241], v9 offset:0
    ds_read_b64_tr_b16 a[242:243], v9 offset:1024
    v_mfma_f32_16x16x32_bf16 v[164:167], a[228:231], v[228:231], v[164:167]
    s_add_u32 m0, s59, 114688
    s_add_u32 s67, s64, 0
    ds_read_b64_tr_b16 a[244:245], v10 offset:0
    v_mfma_f32_16x16x32_bf16 v[168:171], a[232:235], v[228:231], v[168:171]
    buffer_load_dwordx4 v24, s[44:47], s67 offen offset:0 lds
    v_mfma_f32_16x16x32_bf16 v[172:175], a[236:239], v[228:231], v[172:175]
    ds_read_b64_tr_b16 a[246:247], v10 offset:1024
    ds_read_b64_tr_b16 a[248:249], v9 offset:8192
    v_mfma_f32_16x16x32_bf16 v[176:179], a[224:227], v[232:235], v[176:179]
    ds_read_b64_tr_b16 a[250:251], v9 offset:9216
    ds_read_b64_tr_b16 a[252:253], v10 offset:8192
    v_mfma_f32_16x16x32_bf16 v[180:183], a[228:231], v[232:235], v[180:183]
    ds_read_b64_tr_b16 a[254:255], v10 offset:9216
    v_mfma_f32_16x16x32_bf16 v[184:187], a[232:235], v[232:235], v[184:187]
    buffer_load_dwordx4 v25, s[44:47], s67 offen offset:1024 lds
    v_mfma_f32_16x16x32_bf16 v[188:191], a[236:239], v[232:235], v[188:191]
    ds_read_b128 v[240:243], v12 offset:57344
    ds_read_b128 v[244:247], v12 offset:59392
    v_mfma_f32_16x16x32_bf16 v[192:195], a[224:227], v[236:239], v[192:195]
    ds_read_b128 v[248:251], v12 offset:61440
    v_mfma_f32_16x16x32_bf16 v[196:199], a[228:231], v[236:239], v[196:199]
    buffer_load_dwordx4 v26, s[44:47], s67 offen offset:2048 lds
    v_mfma_f32_16x16x32_bf16 v[200:203], a[232:235], v[236:239], v[200:203]
    ds_read_b128 v[252:255], v12 offset:63488
    ds_read_u8 v21, v0
    v_mfma_f32_16x16x32_bf16 v[204:207], a[236:239], v[236:239], v[204:207]
    s_waitcnt lgkmcnt(4)
    v_smfmac_f32_16x16x64_bf16 v[56:59], v[64:67], a[240:247], v13
    v_smfmac_f32_16x16x64_bf16 v[60:63], v[64:67], a[248:255], v13
    s_waitcnt lgkmcnt(3)
    buffer_load_dwordx4 v27, s[44:47], s67 offen offset:3072 lds
    v_mfma_f32_16x16x32_bf16 v[144:147], a[240:243], v[240:243], v[144:147]
    v_mfma_f32_16x16x32_bf16 v[148:151], a[244:247], v[240:243], v[148:151]
    s_add_u32 m0, s59, 131072
    s_add_u32 s67, s64, 131072
    v_mfma_f32_16x16x32_bf16 v[152:155], a[248:251], v[240:243], v[152:155]
    buffer_load_dwordx4 v24, s[44:47], s67 offen offset:0 lds
    v_mfma_f32_16x16x32_bf16 v[156:159], a[252:255], v[240:243], v[156:159]
    s_waitcnt lgkmcnt(1)
    v_mfma_f32_16x16x32_bf16 v[160:163], a[240:243], v[244:247], v[160:163]
    v_add_f32 v56, v56, v57
    v_add_f32 v58, v58, v59
    v_mfma_f32_16x16x32_bf16 v[164:167], a[244:247], v[244:247], v[164:167]
    v_add_f32 v60, v60, v61
    v_add_f32 v62, v62, v63
    v_mfma_f32_16x16x32_bf16 v[168:171], a[248:251], v[244:247], v[168:171]
    buffer_load_dwordx4 v25, s[44:47], s67 offen offset:1024 lds
    v_cvt_pk_bf16_f32 v49, v56, 0
    v_mfma_f32_16x16x32_bf16 v[172:175], a[252:255], v[244:247], v[172:175]
    s_waitcnt vmcnt(11)
    s_barrier
    v_lshlrev_b32 v57, 16, v49
    v_mfma_f32_16x16x32_bf16 v[176:179], a[240:243], v[248:251], v[176:179]
    ds_read_b128 v[224:227], v11 offset:0
    ds_read_b128 v[40:43], v16 offset:0
    v_mfma_f32_16x16x32_bf16 v[180:183], a[244:247], v[248:251], v[180:183]
    ds_read_b128 v[228:231], v12 offset:0
    ds_read_b128 v[44:47], v16 offset:256
    v_mfma_f32_16x16x32_bf16 v[184:187], a[248:251], v[248:251], v[184:187]
    buffer_load_dwordx4 v26, s[44:47], s67 offen offset:2048 lds
    v_sub_f32 v57, v56, v57
    v_mfma_f32_16x16x32_bf16 v[188:191], a[252:255], v[248:251], v[188:191]
    ds_read_b128 v[232:235], v11 offset:2048
    ds_read_b128 v[236:239], v12 offset:2048
    v_mfma_f32_16x16x32_bf16 v[192:195], a[240:243], v[252:255], v[192:195]
    ds_read_b128 v[68:71], v16 offset:512
    ds_read_b128 v[72:75], v16 offset:768
    v_mfma_f32_16x16x32_bf16 v[196:199], a[244:247], v[252:255], v[196:199]
    buffer_load_dwordx4 v27, s[44:47], s67 offen offset:3072 lds
    v_cvt_pk_bf16_f32 v48, v56, v57
    v_mfma_f32_16x16x32_bf16 v[200:203], a[248:251], v[252:255], v[200:203]
    v_cvt_pk_bf16_f32 v51, v58, 0
    v_lshlrev_b32 v59, 16, v51
    v_mfma_f32_16x16x32_bf16 v[204:207], a[252:255], v[252:255], v[204:207]
    s_waitcnt lgkmcnt(7)
    v_sub_f32 v59, v58, v59
    v_cvt_pk_bf16_f32 v50, v58, v59
    v_mfma_f32_16x16x32_bf16 v[208:211], a[0:3], v[224:227], 0
    ds_read_b128 v[240:243], v11 offset:4096
    s_add_u32 m0, s59, 65536
    s_add_u32 s75, s84, 1573888
    v_cvt_pk_bf16_f32 v53, v60, 0
    v_lshlrev_b32 v61, 16, v53
    v_mfma_f32_16x16x32_bf16 v[212:215], a[4:7], v[224:227], 0
    v_sub_f32 v61, v60, v61
    v_cvt_pk_bf16_f32 v52, v60, v61
    v_cvt_pk_bf16_f32 v55, v62, 0
    v_lshlrev_b32 v63, 16, v55
    v_sub_f32 v63, v62, v63
    v_cvt_pk_bf16_f32 v54, v62, v63
    v_mfma_f32_16x16x32_bf16 v[216:219], a[8:11], v[224:227], 0
    v_add_u32 v7, 98304, v28
    v_add_u32 v8, 98304, v29
    v_add_u32 v9, 98304, v30
    v_add_u32 v10, 98304, v31
    v_mfma_f32_16x16x32_bf16 v[220:223], a[12:15], v[224:227], 0
    s_waitcnt lgkmcnt(7)
    buffer_load_dwordx4 v1, s[28:31], s75 offen lds
    v_mfma_f32_16x16x16_bf16 v[144:147], v[48:49], v[40:41], v[144:147]
    v_mfma_f32_16x16x16_bf16 v[148:151], v[50:51], v[40:41], v[148:151]
    v_mfma_f32_16x16x16_bf16 v[152:155], v[52:53], v[40:41], v[152:155]
    s_waitcnt lgkmcnt(6)
    v_mfma_f32_16x16x16_bf16 v[156:159], v[54:55], v[40:41], v[156:159]
    buffer_load_dwordx4 v2, s[28:31], s75 offen offset:1024 lds
    s_add_u32 m0, s59, 67584
    s_add_u32 s75, s85, 1573888
    v_mfma_f32_16x16x32_bf16 v[208:211], a[16:19], v[228:231], v[208:211]
    ds_read_b128 v[224:227], v12 offset:4096
    v_mfma_f32_16x16x32_bf16 v[212:215], a[20:23], v[228:231], v[212:215]
    v_mfma_f32_16x16x32_bf16 v[216:219], a[24:27], v[228:231], v[216:219]
    v_mul_f32 v144, v42, v144
    v_mul_f32 v145, v42, v145
    v_mul_f32 v146, v42, v146
    v_mfma_f32_16x16x32_bf16 v[220:223], a[28:31], v[228:231], v[220:223]
    s_waitcnt lgkmcnt(6)
    v_mul_f32 v147, v42, v147
    v_mul_f32 v148, v42, v148
    v_mfma_f32_16x16x16_bf16 v[160:163], v[48:49], v[44:45], v[160:163]
    buffer_load_dwordx4 v1, s[28:31], s75 offen lds
    v_mul_f32 v149, v42, v149
    v_mfma_f32_16x16x16_bf16 v[164:167], v[50:51], v[44:45], v[164:167]
    v_mul_f32 v150, v42, v150
    v_mul_f32 v151, v42, v151
    v_mfma_f32_16x16x16_bf16 v[168:171], v[52:53], v[44:45], v[168:171]
    s_waitcnt lgkmcnt(5)
    v_exp_f32 v144, v144
    v_mfma_f32_16x16x16_bf16 v[172:175], v[54:55], v[44:45], v[172:175]
    v_exp_f32 v145, v145
    v_fma_f32 v144, v144, v43, v43
    v_mfma_f32_16x16x32_bf16 v[208:211], a[32:35], v[232:235], v[208:211]
    ds_read_b128 v[228:231], v11 offset:6144
    v_fma_f32 v145, v145, v43, v43
    v_mfma_f32_16x16x32_bf16 v[212:215], a[36:39], v[232:235], v[212:215]
    ds_read_b128 v[56:59], v16 offset:1024
    ds_read_b128 v[60:63], v16 offset:1280
    v_mfma_f32_16x16x32_bf16 v[216:219], a[40:43], v[232:235], v[216:219]
    buffer_load_dwordx4 v2, s[28:31], s75 offen offset:1024 lds
    s_add_u32 m0, s59, 147456
    s_add_u32 s67, s64, 262144
    v_mfma_f32_16x16x32_bf16 v[220:223], a[44:47], v[232:235], v[220:223]
    s_waitcnt lgkmcnt(6)
    v_exp_f32 v146, v146
    v_mfma_f32_16x16x16_bf16 v[176:179], v[48:49], v[68:69], v[176:179]
    v_exp_f32 v147, v147
    v_fma_f32 v146, v146, v43, v43
    v_mfma_f32_16x16x16_bf16 v[180:183], v[50:51], v[68:69], v[180:183]
    buffer_load_dwordx4 v24, s[44:47], s67 offen offset:0 lds
    v_fma_f32 v147, v147, v43, v43
    v_mfma_f32_16x16x16_bf16 v[184:187], v[52:53], v[68:69], v[184:187]
    v_exp_f32 v148, v148
    v_mfma_f32_16x16x16_bf16 v[188:191], v[54:55], v[68:69], v[188:191]
    v_exp_f32 v149, v149
    v_mfma_f32_16x16x32_bf16 v[208:211], a[48:51], v[236:239], v[208:211]
    ds_read_b128 v[232:235], v12 offset:6144
    v_fma_f32 v148, v148, v43, v43
    v_mfma_f32_16x16x32_bf16 v[212:215], a[52:55], v[236:239], v[212:215]
    ds_read_b128 v[64:67], v16 offset:1536
    s_waitcnt vmcnt(14)
    ds_read_b128 v[76:79], v16 offset:1792
    v_fma_f32 v149, v149, v43, v43
    v_mfma_f32_16x16x32_bf16 v[216:219], a[56:59], v[236:239], v[216:219]
    buffer_load_dwordx4 v25, s[44:47], s67 offen offset:1024 lds
    v_mul_f32 v160, v46, v160
    v_mfma_f32_16x16x32_bf16 v[220:223], a[60:63], v[236:239], v[220:223]
    s_waitcnt lgkmcnt(8)
    v_exp_f32 v150, v150
    v_mfma_f32_16x16x16_bf16 v[192:195], v[48:49], v[72:73], v[192:195]
    v_exp_f32 v151, v151
    v_mfma_f32_16x16x16_bf16 v[196:199], v[50:51], v[72:73], v[196:199]
    v_fma_f32 v150, v150, v43, v43
    v_fma_f32 v151, v151, v43, v43
    v_mfma_f32_16x16x16_bf16 v[200:203], v[52:53], v[72:73], v[200:203]
    s_waitcnt lgkmcnt(7)
    v_rcp_f32 v144, v144
    s_nop 0
    v_mul_f32 v152, v152, v144
    v_mfma_f32_16x16x16_bf16 v[204:207], v[54:55], v[72:73], v[204:207]
    buffer_load_dwordx4 v26, s[44:47], s67 offen offset:2048 lds
    v_mul_f32 v161, v46, v161
    v_mfma_f32_16x16x32_bf16 v[208:211], a[64:67], v[240:243], v[208:211]
    ds_read_b128 v[236:239], v11 offset:8192
    v_mul_f32 v162, v46, v162
    v_mfma_f32_16x16x32_bf16 v[212:215], a[68:71], v[240:243], v[212:215]
    v_rcp_f32 v145, v145
    v_mfma_f32_16x16x32_bf16 v[216:219], a[72:75], v[240:243], v[216:219]
    s_waitcnt lgkmcnt(7)
    v_rcp_f32 v146, v146
    v_mfma_f32_16x16x32_bf16 v[220:223], a[76:79], v[240:243], v[220:223]
    v_rcp_f32 v147, v147
    v_mul_f32 v153, v153, v145
    v_mfma_f32_16x16x32_bf16 v[208:211], a[80:83], v[224:227], v[208:211]
    ds_read_b128 v[240:243], v12 offset:8192
    buffer_load_dwordx4 v27, s[44:47], s67 offen offset:3072 lds
    s_add_u32 m0, s59, 0
    v_mfma_f32_16x16x32_bf16 v[212:215], a[84:87], v[224:227], v[212:215]
    s_add_u32 s67, s64, 393216
    v_rcp_f32 v148, v148
    v_mfma_f32_16x16x32_bf16 v[216:219], a[88:91], v[224:227], v[216:219]
    s_waitcnt lgkmcnt(7)
    v_rcp_f32 v149, v149
    v_mfma_f32_16x16x32_bf16 v[220:223], a[92:95], v[224:227], v[220:223]
    v_rcp_f32 v150, v150
    v_mfma_f32_16x16x32_bf16 v[208:211], a[96:99], v[228:231], v[208:211]
    ds_read_b128 v[224:227], v11 offset:10240
    v_rcp_f32 v151, v151
    v_mfma_f32_16x16x32_bf16 v[212:215], a[100:103], v[228:231], v[212:215]
    buffer_load_dwordx4 v24, s[44:47], s67 offen offset:0 lds
    s_waitcnt vmcnt(13)
    v_mul_f32 v154, v154, v146
    v_mfma_f32_16x16x32_bf16 v[216:219], a[104:107], v[228:231], v[216:219]
    s_waitcnt lgkmcnt(5)
    ds_read_b64_tr_b16 v[80:81], v7 offset:16384
    v_mfma_f32_16x16x32_bf16 v[220:223], a[108:111], v[228:231], v[220:223]
    ds_read_b64_tr_b16 v[82:83], v7 offset:18432
    v_mul_f32 v155, v155, v147
    v_mfma_f32_16x16x32_bf16 v[208:211], a[112:115], v[232:235], v[208:211]
    ds_read_b128 v[228:231], v12 offset:10240
    v_mul_f32 v156, v156, v148
    v_mfma_f32_16x16x32_bf16 v[212:215], a[116:119], v[232:235], v[212:215]
    buffer_load_dwordx4 v25, s[44:47], s67 offen offset:1024 lds
    ds_read_b64_tr_b16 v[84:85], v8 offset:16384
    ds_read_b64_tr_b16 v[86:87], v8 offset:18432
    v_mfma_f32_16x16x32_bf16 v[216:219], a[120:123], v[232:235], v[216:219]
    s_waitcnt lgkmcnt(7)
    v_mul_f32 v157, v157, v149
    v_mul_f32 v158, v158, v150
    v_mfma_f32_16x16x32_bf16 v[220:223], a[124:127], v[232:235], v[220:223]
    v_mul_f32 v159, v159, v151
    v_cvt_pk_bf16_f32 v144, v152, v153
    v_mfma_f32_16x16x32_bf16 v[208:211], a[128:131], v[236:239], v[208:211]
    ds_read_b128 v[232:235], v11 offset:12288
    v_cvt_pk_bf16_f32 v145, v154, v155
    v_mfma_f32_16x16x32_bf16 v[212:215], a[132:135], v[236:239], v[212:215]
    v_cvt_pk_bf16_f32 v146, v156, v157
    v_cvt_pk_bf16_f32 v147, v158, v159
    s_add_u32 s61, s58, 0
    v_mfma_f32_16x16x32_bf16 v[216:219], a[136:139], v[236:239], v[216:219]
    s_waitcnt lgkmcnt(7)
    buffer_load_dwordx4 v26, s[44:47], s67 offen offset:2048 lds
    v_mfma_f32_16x16x32_bf16 v[220:223], a[140:143], v[236:239], v[220:223]
    ds_read_b64_tr_b16 v[88:89], v9 offset:16384
    ds_read_b64_tr_b16 v[90:91], v9 offset:18432
    v_mfma_f32_16x16x32_bf16 v[208:211], a[144:147], v[240:243], v[208:211]
    ds_read_b128 v[236:239], v12 offset:12288
    v_mul_f32 v163, v46, v163
    v_mfma_f32_16x16x32_bf16 v[212:215], a[148:151], v[240:243], v[212:215]
    buffer_store_dwordx4 v[144:147], v17, s[40:43], s61 offen sc1
    v_mfma_f32_16x16x32_bf16 v[216:219], a[152:155], v[240:243], v[216:219]
    s_waitcnt lgkmcnt(9)
    v_mul_f32 v164, v46, v164
    v_mul_f32 v165, v46, v165
    v_mfma_f32_16x16x32_bf16 v[220:223], a[156:159], v[240:243], v[220:223]
    v_mul_f32 v166, v46, v166
    v_mul_f32 v167, v46, v167
    v_mfma_f32_16x16x32_bf16 v[208:211], a[160:163], v[224:227], v[208:211]
    ds_read_b128 v[240:243], v11 offset:14336
    v_mul_f32 v176, v70, v176
    v_mfma_f32_16x16x32_bf16 v[212:215], a[164:167], v[224:227], v[212:215]
    v_exp_f32 v160, v160
    v_mfma_f32_16x16x32_bf16 v[216:219], a[168:171], v[224:227], v[216:219]
    s_waitcnt lgkmcnt(7)
    v_exp_f32 v161, v161
    v_mfma_f32_16x16x32_bf16 v[220:223], a[172:175], v[224:227], v[220:223]
    buffer_load_dwordx4 v27, s[44:47], s67 offen offset:3072 lds
    ds_read_b64_tr_b16 v[92:93], v10 offset:16384
    v_mfma_f32_16x16x32_bf16 v[208:211], a[176:179], v[228:231], v[208:211]
    ds_read_b128 v[224:227], v12 offset:14336
    ds_read_b64_tr_b16 v[94:95], v10 offset:18432
    s_add_u32 m0, s59, 98304
    v_mfma_f32_16x16x32_bf16 v[212:215], a[180:183], v[228:231], v[212:215]
    s_barrier
    s_add_u32 s67, s64, 524288
    v_mfma_f32_16x16x32_bf16 v[216:219], a[184:187], v[228:231], v[216:219]
    s_waitcnt lgkmcnt(7)
    v_exp_f32 v162, v162
    v_mfma_f32_16x16x32_bf16 v[220:223], a[188:191], v[228:231], v[220:223]
    v_exp_f32 v163, v163
    v_mfma_f32_16x16x32_bf16 v[208:211], a[192:195], v[232:235], v[208:211]
    ds_read_b128 v[228:231], v11 offset:16384
    buffer_load_dwordx4 v24, s[44:47], s67 offen offset:0 lds
    s_waitcnt vmcnt(14)
    v_mfma_f32_16x16x32_bf16 v[212:215], a[196:199], v[232:235], v[212:215]
    ds_read_b64_tr_b16 v[96:97], v7 offset:32768
    ds_read_b64_tr_b16 v[98:99], v7 offset:34816
    v_mfma_f32_16x16x32_bf16 v[216:219], a[200:203], v[232:235], v[216:219]
    s_waitcnt lgkmcnt(7)
    v_exp_f32 v164, v164
    v_fma_f32 v160, v160, v47, v47
    v_mfma_f32_16x16x32_bf16 v[220:223], a[204:207], v[232:235], v[220:223]
    v_exp_f32 v165, v165
    v_mfma_f32_16x16x32_bf16 v[208:211], a[208:211], v[236:239], v[208:211]
    ds_read_b128 v[232:235], v12 offset:16384
    v_fma_f32 v161, v161, v47, v47
    v_mfma_f32_16x16x32_bf16 v[212:215], a[212:215], v[236:239], v[212:215]
    buffer_load_dwordx4 v25, s[44:47], s67 offen offset:1024 lds
    ds_read_b64_tr_b16 v[100:101], v8 offset:32768
    ds_read_b64_tr_b16 v[102:103], v8 offset:34816
    v_mfma_f32_16x16x32_bf16 v[216:219], a[216:219], v[236:239], v[216:219]
    s_waitcnt lgkmcnt(9)
    v_exp_f32 v166, v166
    v_mfma_f32_16x16x32_bf16 v[220:223], a[220:223], v[236:239], v[220:223]
    v_exp_f32 v167, v167
    v_mfma_f32_16x16x32_bf16 v[208:211], a[224:227], v[240:243], v[208:211]
    ds_read_b128 v[236:239], v11 offset:18432
    v_fma_f32 v162, v162, v47, v47
    v_mfma_f32_16x16x32_bf16 v[212:215], a[228:231], v[240:243], v[212:215]
    v_fma_f32 v163, v163, v47, v47
    v_fma_f32 v164, v164, v47, v47
    v_fma_f32 v165, v165, v47, v47
    v_mfma_f32_16x16x32_bf16 v[216:219], a[232:235], v[240:243], v[216:219]
    s_waitcnt lgkmcnt(8)
    buffer_load_dwordx4 v26, s[44:47], s67 offen offset:2048 lds
    v_mfma_f32_16x16x32_bf16 v[220:223], a[236:239], v[240:243], v[220:223]
    ds_read_b64_tr_b16 v[104:105], v9 offset:32768
    ds_read_b64_tr_b16 v[106:107], v9 offset:34816
HG2:
    s_cbranch_execz HBG
    v_mfma_f32_16x16x32_bf16 v[208:211], a[240:243], v[224:227], v[208:211]
    ds_read_b128 v[240:243], v12 offset:18432
    v_fma_f32 v166, v166, v47, v47
    v_fma_f32 v167, v167, v47, v47
    v_mfma_f32_16x16x32_bf16 v[212:215], a[244:247], v[224:227], v[212:215]
    v_rcp_f32 v160, v160
    v_mfma_f32_16x16x32_bf16 v[216:219], a[248:251], v[224:227], v[216:219]
    s_waitcnt lgkmcnt(9)
    v_mul_f32 v168, v168, v160
    v_mfma_f32_16x16x32_bf16 v[220:223], a[252:255], v[224:227], v[220:223]
    buffer_load_dwordx4 v27, s[44:47], s67 offen offset:3072 lds
    ds_read_b64_tr_b16 v[108:109], v10 offset:32768
    ds_read_b64_tr_b16 v[110:111], v10 offset:34816
    v_mfma_f32_16x16x16_bf16 v[144:147], v[48:49], v[60:61], 0
    s_add_u32 m0, s59, 114688
    s_add_u32 s67, s64, 655360
    v_mul_f32 v177, v70, v177
    v_mfma_f32_16x16x16_bf16 v[148:151], v[50:51], v[60:61], 0
    v_rcp_f32 v161, v161
    v_mfma_f32_16x16x16_bf16 v[152:155], v[52:53], v[60:61], 0
    v_rcp_f32 v162, v162
    v_mul_f32 v169, v169, v161
    v_mfma_f32_16x16x16_bf16 v[156:159], v[54:55], v[60:61], 0
    buffer_load_dwordx4 v24, s[44:47], s67 offen offset:0 lds
    s_waitcnt vmcnt(10)
    v_mul_f32 v170, v170, v162
    v_mfma_f32_16x16x32_bf16 v[144:147], a[0:3], v[228:231], v[144:147]
    ds_read_b128 v[224:227], v11 offset:20480
    ds_read_b64_tr_b16 v[112:113], v7 offset:49152
    v_mfma_f32_16x16x32_bf16 v[148:151], a[4:7], v[228:231], v[148:151]
    ds_read_b64_tr_b16 v[114:115], v7 offset:51200
    v_rcp_f32 v163, v163
    v_mfma_f32_16x16x32_bf16 v[152:155], a[8:11], v[228:231], v[152:155]
    v_rcp_f32 v164, v164
    v_mfma_f32_16x16x32_bf16 v[156:159], a[12:15], v[228:231], v[156:159]
    buffer_load_dwordx4 v25, s[44:47], s67 offen offset:1024 lds
    ds_read_b64_tr_b16 v[116:117], v8 offset:49152
    v_mfma_f32_16x16x16_bf16 v[208:211], v[48:49], v[56:57], v[208:211]
    ds_read_b64_tr_b16 v[118:119], v8 offset:51200
    v_mul_f32 v171, v171, v163
    v_mfma_f32_16x16x16_bf16 v[212:215], v[50:51], v[56:57], v[212:215]
    v_rcp_f32 v165, v165
    v_mul_f32 v172, v172, v164
    v_mfma_f32_16x16x16_bf16 v[216:219], v[52:53], v[56:57], v[216:219]
    s_waitcnt lgkmcnt(13)
    v_rcp_f32 v166, v166
    v_mul_f32 v173, v173, v165
    v_mfma_f32_16x16x16_bf16 v[220:223], v[54:55], v[56:57], v[220:223]
    v_rcp_f32 v167, v167
    v_mul_f32 v174, v174, v166
    v_mfma_f32_16x16x32_bf16 v[144:147], a[16:19], v[232:235], v[144:147]
    ds_read_b128 v[228:231], v12 offset:20480
    buffer_load_dwordx4 v26, s[44:47], s67 offen offset:2048 lds
    v_mfma_f32_16x16x32_bf16 v[148:151], a[20:23], v[232:235], v[148:151]
    ds_read_b64_tr_b16 v[120:121], v9 offset:49152
    ds_read_b64_tr_b16 v[122:123], v9 offset:51200
    v_mul_f32 v175, v175, v167
    v_mfma_f32_16x16x32_bf16 v[152:155], a[24:27], v[232:235], v[152:155]
    s_waitcnt lgkmcnt(13)
    v_cvt_pk_bf16_f32 v160, v168, v169
    v_cvt_pk_bf16_f32 v161, v170, v171
    v_cvt_pk_bf16_f32 v162, v172, v173
    v_cvt_pk_bf16_f32 v163, v174, v175
    v_mfma_f32_16x16x32_bf16 v[156:159], a[28:31], v[232:235], v[156:159]
    s_add_u32 s61, s58, 229376
    buffer_store_dwordx4 v[160:163], v17, s[40:43], s61 offen sc1
    v_mfma_f32_16x16x32_bf16 v[144:147], a[32:35], v[236:239], v[144:147]
    ds_read_b128 v[232:235], v11 offset:22528
    v_mul_f32 v178, v70, v178
    v_mfma_f32_16x16x32_bf16 v[148:151], a[36:39], v[236:239], v[148:151]
    s_barrier
    v_mul_f32 v179, v70, v179
    v_mfma_f32_16x16x32_bf16 v[152:155], a[40:43], v[236:239], v[152:155]
    s_waitcnt lgkmcnt(11)
    v_mul_f32 v180, v70, v180
    v_mul_f32 v181, v70, v181
    v_mfma_f32_16x16x32_bf16 v[156:159], a[44:47], v[236:239], v[156:159]
    v_mul_f32 v182, v70, v182
    v_mul_f32 v183, v70, v183
    v_mfma_f32_16x16x32_bf16 v[144:147], a[48:51], v[240:243], v[144:147]
    ds_read_b128 v[236:239], v12 offset:22528
    buffer_load_dwordx4 v27, s[44:47], s67 offen offset:3072 lds
    v_mfma_f32_16x16x32_bf16 v[148:151], a[52:55], v[240:243], v[148:151]
    ds_read_b64_tr_b16 v[124:125], v10 offset:49152
    ds_read_b64_tr_b16 v[126:127], v10 offset:51200
    s_waitcnt lgkmcnt(12)
    v_mfma_f32_16x16x32_bf16 v[152:155], a[56:59], v[240:243], v[152:155]
    s_waitcnt lgkmcnt(11)
    s_add_u32 m0, s59, 131072
    s_add_u32 s67, s64, 786432
    v_mfma_f32_16x16x32_bf16 v[156:159], a[60:63], v[240:243], v[156:159]
    v_exp_f32 v176, v176
    v_mfma_f32_16x16x32_bf16 v[144:147], a[64:67], v[224:227], v[144:147]
    ds_read_b128 v[240:243], v11 offset:24576
    v_exp_f32 v177, v177
    v_mfma_f32_16x16x32_bf16 v[148:151], a[68:71], v[224:227], v[148:151]
    buffer_load_dwordx4 v24, s[44:47], s67 offen offset:0 lds
    s_waitcnt vmcnt(10)
    v_fma_f32 v176, v176, v71, v71
    v_mfma_f32_16x16x32_bf16 v[152:155], a[72:75], v[224:227], v[152:155]
    s_waitcnt lgkmcnt(7)
    ds_read_b64_tr_b16 v[128:129], v28 offset:0
    ds_read_b64_tr_b16 v[130:131], v28 offset:2048
    v_mfma_f32_16x16x32_bf16 v[156:159], a[76:79], v[224:227], v[156:159]
    v_exp_f32 v178, v178
    v_mfma_f32_16x16x32_bf16 v[144:147], a[80:83], v[228:231], v[144:147]
    ds_read_b128 v[224:227], v12 offset:24576
    v_exp_f32 v179, v179
    v_mfma_f32_16x16x32_bf16 v[148:151], a[84:87], v[228:231], v[148:151]
    buffer_load_dwordx4 v25, s[44:47], s67 offen offset:1024 lds
    ds_read_b64_tr_b16 v[132:133], v29 offset:0
    v_mfma_f32_16x16x32_bf16 v[152:155], a[88:91], v[228:231], v[152:155]
    s_waitcnt lgkmcnt(8)
    ds_read_b64_tr_b16 v[134:135], v29 offset:2048
    v_fma_f32 v177, v177, v71, v71
    v_mfma_f32_16x16x32_bf16 v[156:159], a[92:95], v[228:231], v[156:159]
    v_exp_f32 v180, v180
    v_mfma_f32_16x16x32_bf16 v[144:147], a[96:99], v[232:235], v[144:147]
    ds_read_b128 v[228:231], v11 offset:26624
    v_exp_f32 v181, v181
    v_mfma_f32_16x16x32_bf16 v[148:151], a[100:103], v[232:235], v[148:151]
    buffer_load_dwordx4 v26, s[44:47], s67 offen offset:2048 lds
    ds_read_b64_tr_b16 v[136:137], v30 offset:0
    v_mfma_f32_16x16x32_bf16 v[152:155], a[104:107], v[232:235], v[152:155]
    s_waitcnt lgkmcnt(10)
    ds_read_b64_tr_b16 v[138:139], v30 offset:2048
    v_fma_f32 v178, v178, v71, v71
    v_mfma_f32_16x16x32_bf16 v[156:159], a[108:111], v[232:235], v[156:159]
    v_exp_f32 v182, v182
    v_fma_f32 v179, v179, v71, v71
    v_mfma_f32_16x16x32_bf16 v[144:147], a[112:115], v[236:239], v[144:147]
    ds_read_b128 v[232:235], v12 offset:26624
    v_fma_f32 v180, v180, v71, v71
    v_mfma_f32_16x16x32_bf16 v[148:151], a[116:119], v[236:239], v[148:151]
    v_exp_f32 v183, v183
    v_fma_f32 v181, v181, v71, v71
    v_mfma_f32_16x16x32_bf16 v[152:155], a[120:123], v[236:239], v[152:155]
    s_waitcnt lgkmcnt(9)
    buffer_load_dwordx4 v27, s[44:47], s67 offen offset:3072 lds
    v_mfma_f32_16x16x32_bf16 v[156:159], a[124:127], v[236:239], v[156:159]
    ds_read_b64_tr_b16 v[140:141], v31 offset:0
    ds_read_b64_tr_b16 v[142:143], v31 offset:2048
    s_add_u32 m0, s59, 147456
    v_mfma_f32_16x16x32_bf16 v[144:147], a[128:131], v[240:243], v[144:147]
    ds_read_b128 v[236:239], v11 offset:28672
    s_add_u32 s67, s62, 917504
    v_fma_f32 v182, v182, v71, v71
    v_fma_f32 v183, v183, v71, v71
    v_mfma_f32_16x16x32_bf16 v[148:151], a[132:135], v[240:243], v[148:151]
    v_rcp_f32 v176, v176
    v_mfma_f32_16x16x32_bf16 v[152:155], a[136:139], v[240:243], v[152:155]
    s_waitcnt lgkmcnt(9)
    buffer_load_dwordx4 v24, s[44:47], s67 offen offset:0 lds
    v_mul_f32 v184, v184, v176
    v_mfma_f32_16x16x32_bf16 v[156:159], a[140:143], v[240:243], v[156:159]
    v_rcp_f32 v177, v177
    s_nop 0
    v_mul_f32 v185, v185, v177
    v_mfma_f32_16x16x32_bf16 v[144:147], a[144:147], v[224:227], v[144:147]
    ds_read_b128 v[240:243], v12 offset:28672
    v_cvt_pk_bf16_f32 v176, v184, v185
    v_mfma_f32_16x16x32_bf16 v[148:151], a[148:151], v[224:227], v[148:151]
    v_rcp_f32 v178, v178
    s_nop 0
    v_mul_f32 v186, v186, v178
    v_mfma_f32_16x16x32_bf16 v[152:155], a[152:155], v[224:227], v[152:155]
    s_waitcnt lgkmcnt(7)
    buffer_load_dwordx4 v25, s[44:47], s67 offen offset:1024 lds
    v_mul_f32 v192, v74, v192
    v_mfma_f32_16x16x32_bf16 v[156:159], a[156:159], v[224:227], v[156:159]
    v_rcp_f32 v179, v179
    s_nop 0
    v_mul_f32 v187, v187, v179
    v_mfma_f32_16x16x32_bf16 v[144:147], a[160:163], v[228:231], v[144:147]
    ds_read_b128 v[224:227], v11 offset:30720
    v_cvt_pk_bf16_f32 v177, v186, v187
    v_mfma_f32_16x16x32_bf16 v[148:151], a[164:167], v[228:231], v[148:151]
    v_rcp_f32 v180, v180
    s_nop 0
    v_mul_f32 v188, v188, v180
    v_mfma_f32_16x16x32_bf16 v[152:155], a[168:171], v[228:231], v[152:155]
    s_waitcnt lgkmcnt(5)
    v_rcp_f32 v181, v181
    s_nop 0
    v_mul_f32 v189, v189, v181
    v_mfma_f32_16x16x32_bf16 v[156:159], a[172:175], v[228:231], v[156:159]
    buffer_load_dwordx4 v26, s[44:47], s67 offen offset:2048 lds
    v_rcp_f32 v182, v182
    v_mfma_f32_16x16x32_bf16 v[144:147], a[176:179], v[232:235], v[144:147]
    ds_read_b128 v[228:231], v12 offset:30720
    v_mul_f32 v190, v190, v182
    v_mfma_f32_16x16x32_bf16 v[148:151], a[180:183], v[232:235], v[148:151]
    v_rcp_f32 v183, v183
    s_nop 0
    v_mul_f32 v191, v191, v183
    v_mfma_f32_16x16x32_bf16 v[152:155], a[184:187], v[232:235], v[152:155]
    s_waitcnt lgkmcnt(3)
    v_cvt_pk_bf16_f32 v178, v188, v189
    v_cvt_pk_bf16_f32 v179, v190, v191
    s_add_u32 s61, s58, 57344
    v_mfma_f32_16x16x32_bf16 v[156:159], a[188:191], v[232:235], v[156:159]
    buffer_load_dwordx4 v27, s[44:47], s67 offen offset:3072 lds
    s_add_u32 m0, s59, 0
    s_add_u32 s67, s62, 1048576
    v_mfma_f32_16x16x32_bf16 v[144:147], a[192:195], v[236:239], v[144:147]
    ds_read_b128 v[232:235], v11 offset:32768
    v_mul_f32 v193, v74, v193
    v_mul_f32 v194, v74, v194
    v_mfma_f32_16x16x32_bf16 v[148:151], a[196:199], v[236:239], v[148:151]
    buffer_store_dwordx4 v[176:179], v17, s[40:43], s61 offen sc1
    v_mfma_f32_16x16x32_bf16 v[152:155], a[200:203], v[236:239], v[152:155]
    s_waitcnt lgkmcnt(3)
    v_mul_f32 v195, v74, v195
    v_mul_f32 v196, v74, v196
    v_mfma_f32_16x16x32_bf16 v[156:159], a[204:207], v[236:239], v[156:159]
    v_mul_f32 v197, v74, v197
    v_mul_f32 v198, v74, v198
    v_mfma_f32_16x16x32_bf16 v[144:147], a[208:211], v[240:243], v[144:147]
    ds_read_b128 v[236:239], v12 offset:32768
    v_mul_f32 v199, v74, v199
    v_mfma_f32_16x16x32_bf16 v[148:151], a[212:215], v[240:243], v[148:151]
    s_waitcnt vmcnt(10)
    s_atomic_add s56, s[26:27], s52 offset:0
    v_exp_f32 v192, v192
    v_mfma_f32_16x16x32_bf16 v[152:155], a[216:219], v[240:243], v[152:155]
    s_waitcnt lgkmcnt(3)
    v_exp_f32 v193, v193
    v_fma_f32 v192, v192, v75, v75
    v_mfma_f32_16x16x32_bf16 v[156:159], a[220:223], v[240:243], v[156:159]
    buffer_load_dwordx4 v24, s[44:47], s67 offen offset:0 lds
    v_fma_f32 v193, v193, v75, v75
    v_mfma_f32_16x16x32_bf16 v[144:147], a[224:227], v[224:227], v[144:147]
    ds_read_b128 v[240:243], v11 offset:34816
    ds_read_b64_tr_b16 v[160:161], v7 offset:0
    ds_read_b64_tr_b16 v[162:163], v7 offset:2048
    v_mfma_f32_16x16x32_bf16 v[148:151], a[228:231], v[224:227], v[148:151]
    v_exp_f32 v194, v194
    s_nop 0
    v_fma_f32 v194, v194, v75, v75
    v_mfma_f32_16x16x32_bf16 v[152:155], a[232:235], v[224:227], v[152:155]
    s_waitcnt lgkmcnt(5)
    v_exp_f32 v195, v195
    s_nop 0
    v_fma_f32 v195, v195, v75, v75
    v_mfma_f32_16x16x32_bf16 v[156:159], a[236:239], v[224:227], v[156:159]
    buffer_load_dwordx4 v25, s[44:47], s67 offen offset:1024 lds
    ds_read_b64_tr_b16 v[164:165], v8 offset:0
    ds_read_b64_tr_b16 v[166:167], v8 offset:2048
    v_mfma_f32_16x16x32_bf16 v[144:147], a[240:243], v[228:231], v[144:147]
    ds_read_b128 v[224:227], v12 offset:34816
    v_exp_f32 v196, v196
    v_mfma_f32_16x16x32_bf16 v[148:151], a[244:247], v[228:231], v[148:151]
    s_barrier
    v_exp_f32 v197, v197
    v_fma_f32 v196, v196, v75, v75
    v_mfma_f32_16x16x32_bf16 v[152:155], a[248:251], v[228:231], v[152:155]
    s_waitcnt lgkmcnt(7)
    v_exp_f32 v198, v198
    v_fma_f32 v197, v197, v75, v75
    v_mfma_f32_16x16x32_bf16 v[156:159], a[252:255], v[228:231], v[156:159]
    buffer_load_dwordx4 v26, s[44:47], s67 offen offset:2048 lds
    ds_read_b64_tr_b16 v[168:169], v9 offset:0
    ds_read_b64_tr_b16 v[170:171], v9 offset:2048
    v_mfma_f32_16x16x16_bf16 v[176:179], v[48:49], v[64:65], 0
    v_exp_f32 v199, v199
    v_fma_f32 v198, v198, v75, v75
    v_mfma_f32_16x16x16_bf16 v[180:183], v[50:51], v[64:65], 0
    v_fma_f32 v199, v199, v75, v75
    v_rcp_f32 v192, v192
    v_mfma_f32_16x16x16_bf16 v[184:187], v[52:53], v[64:65], 0
    v_rcp_f32 v193, v193
    v_rcp_f32 v194, v194
    v_mfma_f32_16x16x16_bf16 v[188:191], v[54:55], v[64:65], 0
    buffer_load_dwordx4 v27, s[44:47], s67 offen offset:3072 lds
    ds_read_b64_tr_b16 v[172:173], v10 offset:0
    ds_read_b64_tr_b16 v[174:175], v10 offset:2048
    s_add_u32 m0, s59, 16384
    v_mfma_f32_16x16x32_bf16 v[176:179], a[0:3], v[232:235], v[176:179]
    ds_read_b128 v[228:231], v11 offset:36864
    s_add_u32 s67, s62, 1310720
    v_rcp_f32 v195, v195
    v_mul_f32 v200, v200, v192
    v_mfma_f32_16x16x32_bf16 v[180:183], a[4:7], v[232:235], v[180:183]
    v_rcp_f32 v196, v196
    v_mul_f32 v201, v201, v193
    v_mfma_f32_16x16x32_bf16 v[184:187], a[8:11], v[232:235], v[184:187]
    s_waitcnt lgkmcnt(11)
    v_rcp_f32 v197, v197
    v_rcp_f32 v198, v198
    v_mfma_f32_16x16x32_bf16 v[188:191], a[12:15], v[232:235], v[188:191]
    buffer_load_dwordx4 v24, s[44:47], s67 offen offset:0 lds
    v_rcp_f32 v199, v199
    v_mfma_f32_16x16x32_bf16 v[176:179], a[16:19], v[236:239], v[176:179]
    ds_read_b128 v[232:235], v12 offset:36864
    v_mul_f32 v202, v202, v194
    v_mul_f32 v203, v203, v195
    v_mul_f32 v204, v204, v196
    v_mfma_f32_16x16x32_bf16 v[180:183], a[20:23], v[236:239], v[180:183]
    v_mul_f32 v205, v205, v197
    v_mul_f32 v206, v206, v198
    v_mul_f32 v207, v207, v199
    v_mfma_f32_16x16x32_bf16 v[184:187], a[24:27], v[236:239], v[184:187]
    s_waitcnt lgkmcnt(11)
    buffer_load_dwordx4 v25, s[44:47], s67 offen offset:1024 lds
    v_cvt_pk_bf16_f32 v192, v200, v201
    v_cvt_pk_bf16_f32 v193, v202, v203
    v_mfma_f32_16x16x32_bf16 v[188:191], a[28:31], v[236:239], v[188:191]
    v_cvt_pk_bf16_f32 v194, v204, v205
    v_cvt_pk_bf16_f32 v195, v206, v207
    s_add_u32 s61, s58, 286720
    v_mul_f32 v208, v58, v208
    v_mfma_f32_16x16x32_bf16 v[176:179], a[32:35], v[240:243], v[176:179]
    ds_read_b128 v[236:239], v11 offset:38912
    v_mul_f32 v209, v58, v209
    v_mul_f32 v210, v58, v210
    v_mul_f32 v211, v58, v211
    v_mul_f32 v212, v58, v212
    v_mul_f32 v213, v58, v213
    v_mul_f32 v214, v58, v214
    buffer_store_dwordx4 v[192:195], v17, s[40:43], s61 offen sc1
    v_mfma_f32_16x16x32_bf16 v[180:183], a[36:39], v[240:243], v[180:183]
    v_mul_f32 v215, v58, v215
    v_mul_f32 v144, v62, v144
    v_mfma_f32_16x16x32_bf16 v[184:187], a[40:43], v[240:243], v[184:187]
    s_waitcnt lgkmcnt(7)
    v_exp_f32 v208, v208
    v_mfma_f32_16x16x32_bf16 v[188:191], a[44:47], v[240:243], v[188:191]
    v_exp_f32 v209, v209
    v_mfma_f32_16x16x32_bf16 v[176:179], a[48:51], v[224:227], v[176:179]
    ds_read_b128 v[240:243], v12 offset:38912
    buffer_load_dwordx4 v26, s[44:47], s67 offen offset:2048 lds
    v_mfma_f32_16x16x32_bf16 v[180:183], a[52:55], v[224:227], v[180:183]
    v_exp_f32 v210, v210
    v_mfma_f32_16x16x32_bf16 v[184:187], a[56:59], v[224:227], v[184:187]
    s_waitcnt lgkmcnt(3)
    v_exp_f32 v211, v211
    v_mfma_f32_16x16x32_bf16 v[188:191], a[60:63], v[224:227], v[188:191]
    v_exp_f32 v212, v212
    v_mfma_f32_16x16x32_bf16 v[176:179], a[64:67], v[228:231], v[176:179]
    ds_read_b128 v[224:227], v11 offset:40960
    v_fma_f32 v208, v208, v59, v59
    v_mfma_f32_16x16x32_bf16 v[180:183], a[68:71], v[228:231], v[180:183]
    buffer_load_dwordx4 v27, s[44:47], s67 offen offset:3072 lds
    s_add_u32 m0, s59, 98304
    v_mfma_f32_16x16x32_bf16 v[184:187], a[72:75], v[228:231], v[184:187]
    s_waitcnt lgkmcnt(3)
    s_add_u32 s67, s62, 1179648
    v_fma_f32 v209, v209, v59, v59
    v_mfma_f32_16x16x32_bf16 v[188:191], a[76:79], v[228:231], v[188:191]
    v_exp_f32 v213, v213
    v_fma_f32 v210, v210, v59, v59
    v_mfma_f32_16x16x32_bf16 v[176:179], a[80:83], v[232:235], v[176:179]
    ds_read_b128 v[228:231], v12 offset:40960
    v_fma_f32 v211, v211, v59, v59
    v_mfma_f32_16x16x32_bf16 v[180:183], a[84:87], v[232:235], v[180:183]
    v_exp_f32 v214, v214
    v_mfma_f32_16x16x32_bf16 v[184:187], a[88:91], v[232:235], v[184:187]
    s_waitcnt lgkmcnt(3)
    buffer_load_dwordx4 v24, s[44:47], s67 offen offset:0 lds
    v_fma_f32 v212, v212, v59, v59
    v_mfma_f32_16x16x32_bf16 v[188:191], a[92:95], v[232:235], v[188:191]
    v_exp_f32 v215, v215
    v_mfma_f32_16x16x32_bf16 v[176:179], a[96:99], v[236:239], v[176:179]
    ds_read_b128 v[232:235], v11 offset:43008
    v_fma_f32 v213, v213, v59, v59
    v_mfma_f32_16x16x32_bf16 v[180:183], a[100:103], v[236:239], v[180:183]
    v_fma_f32 v214, v214, v59, v59
    v_fma_f32 v215, v215, v59, v59
    v_mul_f32 v145, v62, v145
    v_mfma_f32_16x16x32_bf16 v[184:187], a[104:107], v[236:239], v[184:187]
    s_waitcnt lgkmcnt(3)
    buffer_load_dwordx4 v25, s[44:47], s67 offen offset:1024 lds
    v_mfma_f32_16x16x32_bf16 v[188:191], a[108:111], v[236:239], v[188:191]
    v_rcp_f32 v208, v208
    v_mfma_f32_16x16x32_bf16 v[176:179], a[112:115], v[240:243], v[176:179]
    ds_read_b128 v[236:239], v12 offset:43008
    v_rcp_f32 v209, v209
    v_mfma_f32_16x16x32_bf16 v[180:183], a[116:119], v[240:243], v[180:183]
    v_rcp_f32 v210, v210
    v_mfma_f32_16x16x32_bf16 v[184:187], a[120:123], v[240:243], v[184:187]
    s_waitcnt lgkmcnt(3)
    v_rcp_f32 v211, v211
    v_mfma_f32_16x16x32_bf16 v[188:191], a[124:127], v[240:243], v[188:191]
    buffer_load_dwordx4 v26, s[44:47], s67 offen offset:2048 lds
    v_rcp_f32 v212, v212
    v_mfma_f32_16x16x32_bf16 v[176:179], a[128:131], v[224:227], v[176:179]
    ds_read_b128 v[240:243], v11 offset:45056
    v_mul_f32 v216, v216, v208
    v_mfma_f32_16x16x32_bf16 v[180:183], a[132:135], v[224:227], v[180:183]
    v_rcp_f32 v213, v213
    v_mul_f32 v217, v217, v209
    v_mfma_f32_16x16x32_bf16 v[184:187], a[136:139], v[224:227], v[184:187]
    s_waitcnt lgkmcnt(3)
    v_rcp_f32 v214, v214
    v_mfma_f32_16x16x32_bf16 v[188:191], a[140:143], v[224:227], v[188:191]
    v_rcp_f32 v215, v215
    v_mfma_f32_16x16x32_bf16 v[176:179], a[144:147], v[228:231], v[176:179]
    ds_read_b128 v[224:227], v12 offset:45056
    buffer_load_dwordx4 v27, s[44:47], s67 offen offset:3072 lds
    s_add_u32 m0, s59, 32768
    s_add_u32 s67, s62, 1441792
    v_mfma_f32_16x16x32_bf16 v[180:183], a[148:151], v[228:231], v[180:183]
    v_mul_f32 v218, v218, v210
    v_mul_f32 v219, v219, v211
    v_mfma_f32_16x16x32_bf16 v[184:187], a[152:155], v[228:231], v[184:187]
    s_waitcnt lgkmcnt(3)
    v_mul_f32 v220, v220, v212
    v_mul_f32 v221, v221, v213
    v_mfma_f32_16x16x32_bf16 v[188:191], a[156:159], v[228:231], v[188:191]
    v_mul_f32 v222, v222, v214
    v_mul_f32 v223, v223, v215
    v_cvt_pk_bf16_f32 v208, v216, v217
    v_mfma_f32_16x16x32_bf16 v[176:179], a[160:163], v[232:235], v[176:179]
    ds_read_b128 v[228:231], v11 offset:47104
    buffer_load_dwordx4 v24, s[44:47], s67 offen offset:0 lds
    s_waitcnt vmcnt(23)
    v_mfma_f32_16x16x32_bf16 v[180:183], a[164:167], v[232:235], v[180:183]
    ds_read_b64_tr_b16 v[192:193], v7 offset:16384
    ds_read_b64_tr_b16 v[194:195], v7 offset:18432
    v_cvt_pk_bf16_f32 v209, v218, v219
    v_mfma_f32_16x16x32_bf16 v[184:187], a[168:171], v[232:235], v[184:187]
    s_waitcnt lgkmcnt(5)
    v_cvt_pk_bf16_f32 v210, v220, v221
    v_cvt_pk_bf16_f32 v211, v222, v223
    v_mfma_f32_16x16x32_bf16 v[188:191], a[172:175], v[232:235], v[188:191]
    s_add_u32 s61, s58, 114688
    buffer_store_dwordx4 v[208:211], v17, s[40:43], s61 offen sc1
    v_mfma_f32_16x16x32_bf16 v[176:179], a[176:179], v[236:239], v[176:179]
    ds_read_b128 v[232:235], v12 offset:47104
    v_mul_f32 v146, v62, v146
    v_mfma_f32_16x16x32_bf16 v[180:183], a[180:183], v[236:239], v[180:183]
    v_mul_f32 v147, v62, v147
    v_mul_f32 v148, v62, v148
    v_mfma_f32_16x16x32_bf16 v[184:187], a[184:187], v[236:239], v[184:187]
    s_waitcnt lgkmcnt(5)
    v_mul_f32 v149, v62, v149
    v_mul_f32 v150, v62, v150
    v_mfma_f32_16x16x32_bf16 v[188:191], a[188:191], v[236:239], v[188:191]
    v_mul_f32 v151, v62, v151
    v_mfma_f32_16x16x32_bf16 v[176:179], a[192:195], v[240:243], v[176:179]
    ds_read_b128 v[236:239], v11 offset:49152
    v_mfma_f32_16x16x32_bf16 v[180:183], a[196:199], v[240:243], v[180:183]
    buffer_load_dwordx4 v25, s[44:47], s67 offen offset:1024 lds
    ds_read_b64_tr_b16 v[196:197], v8 offset:16384
    v_mfma_f32_16x16x32_bf16 v[184:187], a[200:203], v[240:243], v[184:187]
    s_waitcnt lgkmcnt(6)
    ds_read_b64_tr_b16 v[198:199], v8 offset:18432
    v_mfma_f32_16x16x32_bf16 v[188:191], a[204:207], v[240:243], v[188:191]
    v_exp_f32 v144, v144
    s_nop 0
    v_fma_f32 v144, v144, v63, v63
    v_mfma_f32_16x16x32_bf16 v[176:179], a[208:211], v[224:227], v[176:179]
    ds_read_b128 v[240:243], v12 offset:49152
    v_exp_f32 v145, v145
    v_mfma_f32_16x16x32_bf16 v[180:183], a[212:215], v[224:227], v[180:183]
    buffer_load_dwordx4 v26, s[44:47], s67 offen offset:2048 lds
    ds_read_b64_tr_b16 v[200:201], v9 offset:16384
    v_mfma_f32_16x16x32_bf16 v[184:187], a[216:219], v[224:227], v[184:187]
    s_waitcnt lgkmcnt(8)
    ds_read_b64_tr_b16 v[202:203], v9 offset:18432
    v_fma_f32 v145, v145, v63, v63
    v_mfma_f32_16x16x32_bf16 v[188:191], a[220:223], v[224:227], v[188:191]
    v_exp_f32 v146, v146
    s_nop 0
    v_fma_f32 v146, v146, v63, v63
    v_mfma_f32_16x16x32_bf16 v[176:179], a[224:227], v[228:231], v[176:179]
    ds_read_b128 v[224:227], v11 offset:51200
    v_exp_f32 v147, v147
    v_mfma_f32_16x16x32_bf16 v[180:183], a[228:231], v[228:231], v[180:183]
    s_waitcnt vmcnt(10)
    s_atomic_add s56, s[26:27], s52 offset:128
    v_fma_f32 v147, v147, v63, v63
    v_mfma_f32_16x16x32_bf16 v[184:187], a[232:235], v[228:231], v[184:187]
    s_waitcnt lgkmcnt(7)
    buffer_load_dwordx4 v27, s[44:47], s67 offen offset:3072 lds
    ds_read_b64_tr_b16 v[204:205], v10 offset:16384
    v_mfma_f32_16x16x32_bf16 v[188:191], a[236:239], v[228:231], v[188:191]
    ds_read_b64_tr_b16 v[206:207], v10 offset:18432
    s_lshl_b32 s67, s3, 11
    s_add_u32 m0, s67, 86016
    s_sub_u32 s67, s82, 1024
    v_mfma_f32_16x16x32_bf16 v[176:179], a[240:243], v[232:235], v[176:179]
    ds_read_b128 v[228:231], v12 offset:51200
    ds_read_u8 v21, v0
    v_exp_f32 v148, v148
    v_mfma_f32_16x16x32_bf16 v[180:183], a[244:247], v[232:235], v[180:183]
    s_barrier
    v_exp_f32 v149, v149
    v_fma_f32 v148, v148, v63, v63
    v_mfma_f32_16x16x32_bf16 v[184:187], a[248:251], v[232:235], v[184:187]
    s_waitcnt lgkmcnt(9)
    buffer_load_dwordx4 v19, s[28:31], s80 offen lds
    v_fma_f32 v149, v149, v63, v63
    v_mfma_f32_16x16x32_bf16 v[188:191], a[252:255], v[232:235], v[188:191]
    v_exp_f32 v150, v150
    s_nop 0
    v_fma_f32 v150, v150, v63, v63
    v_mfma_f32_16x16x16_bf16 v[208:211], v[48:49], v[76:77], 0
    v_exp_f32 v151, v151
    s_nop 0
    v_fma_f32 v151, v151, v63, v63
    v_mfma_f32_16x16x16_bf16 v[212:215], v[50:51], v[76:77], 0
    v_rcp_f32 v144, v144
    s_nop 0
    v_mul_f32 v152, v152, v144
    v_mfma_f32_16x16x16_bf16 v[216:219], v[52:53], v[76:77], 0
    buffer_load_dwordx4 v19, s[28:31], s67 offen offset:1024 lds
    s_mov_b32 s57, 0
    s_load_dword s57, s[26:27], s53 offset:0
    s_waitcnt lgkmcnt(2)
    s_add_u32 m0, s59, 114688
    v_mfma_f32_16x16x16_bf16 v[220:223], v[54:55], v[76:77], 0
    s_add_u32 s67, s62, 1572864
    v_rcp_f32 v145, v145
    s_nop 0
    v_mul_f32 v153, v153, v145
    v_mfma_f32_16x16x32_bf16 v[208:211], a[0:3], v[236:239], v[208:211]
    ds_read_b128 v[232:235], v11 offset:53248
    v_rcp_f32 v146, v146
    s_nop 0
    v_mul_f32 v154, v154, v146
    v_mfma_f32_16x16x32_bf16 v[212:215], a[4:7], v[236:239], v[212:215]
    buffer_load_dwordx4 v24, s[44:47], s67 offen offset:0 lds
    v_rcp_f32 v147, v147
    v_mfma_f32_16x16x32_bf16 v[216:219], a[8:11], v[236:239], v[216:219]
    v_rcp_f32 v148, v148
    v_rcp_f32 v149, v149
    v_mfma_f32_16x16x32_bf16 v[220:223], a[12:15], v[236:239], v[220:223]
    v_rcp_f32 v150, v150
    v_rcp_f32 v151, v151
    v_mfma_f32_16x16x32_bf16 v[208:211], a[16:19], v[240:243], v[208:211]
    ds_read_b128 v[236:239], v12 offset:53248
    v_mul_f32 v155, v155, v147
    v_mul_f32 v156, v156, v148
    v_mfma_f32_16x16x32_bf16 v[212:215], a[20:23], v[240:243], v[212:215]
    buffer_load_dwordx4 v25, s[44:47], s67 offen offset:1024 lds
    v_mul_f32 v157, v157, v149
    v_mul_f32 v158, v158, v150
    v_mul_f32 v159, v159, v151
    v_mfma_f32_16x16x32_bf16 v[216:219], a[24:27], v[240:243], v[216:219]
    v_cvt_pk_bf16_f32 v144, v152, v153
    v_cvt_pk_bf16_f32 v145, v154, v155
    v_cvt_pk_bf16_f32 v146, v156, v157
    v_mfma_f32_16x16x32_bf16 v[220:223], a[28:31], v[240:243], v[220:223]
    v_cvt_pk_bf16_f32 v147, v158, v159
    s_add_u32 s61, s58, 344064
    v_mul_f32 v176, v66, v176
    v_mul_f32 v177, v66, v177
    v_mfma_f32_16x16x32_bf16 v[208:211], a[32:35], v[224:227], v[208:211]
    ds_read_b128 v[240:243], v11 offset:55296
    buffer_load_dwordx4 v26, s[44:47], s67 offen offset:2048 lds
    v_mul_f32 v178, v66, v178
    v_mul_f32 v179, v66, v179
    v_mul_f32 v180, v66, v180
    v_mul_f32 v181, v66, v181
    buffer_store_dwordx4 v[144:147], v17, s[40:43], s61 offen sc1
    v_mfma_f32_16x16x32_bf16 v[212:215], a[36:39], v[224:227], v[212:215]
    v_mul_f32 v182, v66, v182
    v_mul_f32 v183, v66, v183
    v_mfma_f32_16x16x32_bf16 v[216:219], a[40:43], v[224:227], v[216:219]
    s_waitcnt lgkmcnt(4)
    v_exp_f32 v176, v176
    v_mfma_f32_16x16x32_bf16 v[220:223], a[44:47], v[224:227], v[220:223]
    v_exp_f32 v177, v177
    v_mfma_f32_16x16x32_bf16 v[208:211], a[48:51], v[228:231], v[208:211]
    ds_read_b128 v[224:227], v12 offset:55296
    v_fma_f32 v176, v176, v67, v67
    v_mfma_f32_16x16x32_bf16 v[212:215], a[52:55], v[228:231], v[212:215]
    v_exp_f32 v178, v178
    v_mfma_f32_16x16x32_bf16 v[216:219], a[56:59], v[228:231], v[216:219]
    s_waitcnt lgkmcnt(3)
    v_exp_f32 v179, v179
    v_mfma_f32_16x16x32_bf16 v[220:223], a[60:63], v[228:231], v[220:223]
    v_exp_f32 v180, v180
    v_mfma_f32_16x16x32_bf16 v[208:211], a[64:67], v[232:235], v[208:211]
    ds_read_b128 v[228:231], v11 offset:57344
    buffer_load_dwordx4 v27, s[44:47], s67 offen offset:3072 lds
    s_add_u32 m0, s59, 49152
    v_mfma_f32_16x16x32_bf16 v[212:215], a[68:71], v[232:235], v[212:215]
    s_add_u32 s67, s62, 1703936
    v_exp_f32 v181, v181
    v_mfma_f32_16x16x32_bf16 v[216:219], a[72:75], v[232:235], v[216:219]
    s_waitcnt lgkmcnt(3)
    v_exp_f32 v182, v182
    v_mfma_f32_16x16x32_bf16 v[220:223], a[76:79], v[232:235], v[220:223]
    v_exp_f32 v183, v183
    v_mfma_f32_16x16x32_bf16 v[208:211], a[80:83], v[236:239], v[208:211]
    ds_read_b128 v[232:235], v12 offset:57344
    v_fma_f32 v177, v177, v67, v67
    v_mfma_f32_16x16x32_bf16 v[212:215], a[84:87], v[236:239], v[212:215]
    buffer_load_dwordx4 v24, s[44:47], s67 offen offset:0 lds
    v_fma_f32 v178, v178, v67, v67
    v_mfma_f32_16x16x32_bf16 v[216:219], a[88:91], v[236:239], v[216:219]
    s_waitcnt lgkmcnt(3)
    v_fma_f32 v179, v179, v67, v67
    v_fma_f32 v180, v180, v67, v67
    v_mfma_f32_16x16x32_bf16 v[220:223], a[92:95], v[236:239], v[220:223]
    v_fma_f32 v181, v181, v67, v67
    v_fma_f32 v182, v182, v67, v67
    v_mfma_f32_16x16x32_bf16 v[208:211], a[96:99], v[240:243], v[208:211]
    ds_read_b128 v[236:239], v11 offset:59392
    v_fma_f32 v183, v183, v67, v67
    v_mfma_f32_16x16x32_bf16 v[212:215], a[100:103], v[240:243], v[212:215]
    v_rcp_f32 v176, v176
    v_mfma_f32_16x16x32_bf16 v[216:219], a[104:107], v[240:243], v[216:219]
    s_waitcnt lgkmcnt(3)
    buffer_load_dwordx4 v25, s[44:47], s67 offen offset:1024 lds
    v_mfma_f32_16x16x32_bf16 v[220:223], a[108:111], v[240:243], v[220:223]
    v_rcp_f32 v177, v177
    v_mfma_f32_16x16x32_bf16 v[208:211], a[112:115], v[224:227], v[208:211]
    ds_read_b128 v[240:243], v12 offset:59392
    v_mul_f32 v184, v184, v176
    v_mfma_f32_16x16x32_bf16 v[212:215], a[116:119], v[224:227], v[212:215]
    v_rcp_f32 v178, v178
    v_mfma_f32_16x16x32_bf16 v[216:219], a[120:123], v[224:227], v[216:219]
    s_waitcnt lgkmcnt(3)
    v_rcp_f32 v179, v179
    v_mfma_f32_16x16x32_bf16 v[220:223], a[124:127], v[224:227], v[220:223]
    buffer_load_dwordx4 v26, s[44:47], s67 offen offset:2048 lds
    v_mul_f32 v185, v185, v177
    v_mfma_f32_16x16x32_bf16 v[208:211], a[128:131], v[228:231], v[208:211]
    ds_read_b128 v[224:227], v11 offset:61440
    v_mul_f32 v186, v186, v178
    v_mfma_f32_16x16x32_bf16 v[212:215], a[132:135], v[228:231], v[212:215]
    v_rcp_f32 v180, v180
    v_mfma_f32_16x16x32_bf16 v[216:219], a[136:139], v[228:231], v[216:219]
    s_waitcnt lgkmcnt(3)
    v_rcp_f32 v181, v181
    v_mfma_f32_16x16x32_bf16 v[220:223], a[140:143], v[228:231], v[220:223]
HG3:
    s_cbranch_execz HBG
    v_rcp_f32 v182, v182
    v_mfma_f32_16x16x32_bf16 v[208:211], a[144:147], v[232:235], v[208:211]
    ds_read_b128 v[228:231], v12 offset:61440
    buffer_load_dwordx4 v27, s[44:47], s67 offen offset:3072 lds
    v_mfma_f32_16x16x32_bf16 v[212:215], a[148:151], v[232:235], v[212:215]
    s_cmp_ge_u32 s57, 14
    s_cbranch_scc0 SL_q0
BK_q0:
    s_add_u32 s68, s66, 0
    v_mfma_f32_16x16x32_bf16 v[216:219], a[152:155], v[232:235], v[216:219]
    s_waitcnt lgkmcnt(3)
    v_rcp_f32 v183, v183
    v_mfma_f32_16x16x32_bf16 v[220:223], a[156:159], v[232:235], v[220:223]
    v_mul_f32 v187, v187, v179
    v_mul_f32 v188, v188, v180
    v_mfma_f32_16x16x32_bf16 v[208:211], a[160:163], v[236:239], v[208:211]
    ds_read_b128 v[232:235], v11 offset:63488
    v_mul_f32 v189, v189, v181
    v_mfma_f32_16x16x32_bf16 v[212:215], a[164:167], v[236:239], v[212:215]
    buffer_load_dwordx4 a[0:3], v17, s[40:43], s68 offen offset:0 sc1
    v_mul_f32 v190, v190, v182
    v_mfma_f32_16x16x32_bf16 v[216:219], a[168:171], v[236:239], v[216:219]
    s_waitcnt lgkmcnt(3)
    v_mul_f32 v191, v191, v183
    v_cvt_pk_bf16_f32 v176, v184, v185
    v_mfma_f32_16x16x32_bf16 v[220:223], a[172:175], v[236:239], v[220:223]
    v_cvt_pk_bf16_f32 v177, v186, v187
    v_cvt_pk_bf16_f32 v178, v188, v189
    v_mfma_f32_16x16x32_bf16 v[208:211], a[176:179], v[240:243], v[208:211]
    ds_read_b128 v[236:239], v12 offset:63488
    ds_read_u8 v21, v0
    v_cvt_pk_bf16_f32 v179, v190, v191
    v_mfma_f32_16x16x32_bf16 v[212:215], a[180:183], v[240:243], v[212:215]
    s_add_u32 s61, s58, 172032
    buffer_store_dwordx4 v[176:179], v17, s[40:43], s61 offen sc1
    v_mfma_f32_16x16x32_bf16 v[216:219], a[184:187], v[240:243], v[216:219]
    s_waitcnt lgkmcnt(3)
    v_mfma_f32_16x16x32_bf16 v[220:223], a[188:191], v[240:243], v[220:223]
    v_mfma_f32_16x16x32_bf16 v[208:211], a[192:195], v[224:227], v[208:211]
    v_mfma_f32_16x16x32_bf16 v[212:215], a[196:199], v[224:227], v[212:215]
    v_mfma_f32_16x16x32_bf16 v[216:219], a[200:203], v[224:227], v[216:219]
    s_waitcnt lgkmcnt(2)
    buffer_load_dwordx4 a[4:7], v17, s[40:43], s68 offen offset:1024 sc1
    v_mfma_f32_16x16x32_bf16 v[220:223], a[204:207], v[224:227], v[220:223]
    v_mfma_f32_16x16x32_bf16 v[208:211], a[208:211], v[228:231], v[208:211]
    v_mfma_f32_16x16x32_bf16 v[212:215], a[212:215], v[228:231], v[212:215]
    v_mfma_f32_16x16x32_bf16 v[216:219], a[216:219], v[228:231], v[216:219]
    s_waitcnt lgkmcnt(1)
    v_mfma_f32_16x16x32_bf16 v[220:223], a[220:223], v[228:231], v[220:223]
    buffer_load_dwordx4 a[8:11], v17, s[40:43], s68 offen offset:2048 sc1
    v_mfma_f32_16x16x32_bf16 v[208:211], a[224:227], v[232:235], v[208:211]
    v_mfma_f32_16x16x32_bf16 v[212:215], a[228:231], v[232:235], v[212:215]
    v_mfma_f32_16x16x32_bf16 v[216:219], a[232:235], v[232:235], v[216:219]
    s_waitcnt lgkmcnt(1)
    v_mfma_f32_16x16x32_bf16 v[220:223], a[236:239], v[232:235], v[220:223]
    v_mfma_f32_16x16x32_bf16 v[208:211], a[240:243], v[236:239], v[208:211]
    buffer_load_dwordx4 a[12:15], v17, s[40:43], s68 offen offset:3072 sc1
    s_add_u32 s68, s66, 4096
    v_mfma_f32_16x16x32_bf16 v[212:215], a[244:247], v[236:239], v[212:215]
    s_waitcnt vmcnt(10)
    s_atomic_add s56, s[26:27], s52 offset:256
    v_mfma_f32_16x16x32_bf16 v[216:219], a[248:251], v[236:239], v[216:219]
    v_mfma_f32_16x16x32_bf16 v[220:223], a[252:255], v[236:239], v[220:223]
    s_nop 0
    v_pk_mul_f32 v[208:209], v[208:209], v[78:79] op_sel_hi:[1,0]
    v_pk_mul_f32 v[210:211], v[210:211], v[78:79] op_sel_hi:[1,0]
    s_nop 0
    v_pk_mul_f32 v[212:213], v[212:213], v[78:79] op_sel_hi:[1,0]
    v_pk_mul_f32 v[214:215], v[214:215], v[78:79] op_sel_hi:[1,0]
    v_exp_f32 v208, v208
    v_exp_f32 v209, v209
    v_exp_f32 v210, v210
    v_exp_f32 v211, v211
    v_exp_f32 v212, v212
    v_exp_f32 v213, v213
    v_exp_f32 v214, v214
    buffer_load_dwordx4 a[16:19], v17, s[40:43], s68 offen offset:0 sc1
    v_exp_f32 v215, v215
    v_pk_fma_f32 v[208:209], v[208:209], v[78:79], v[78:79] op_sel:[0,1,1] op_sel_hi:[1,1,1]
    v_pk_fma_f32 v[210:211], v[210:211], v[78:79], v[78:79] op_sel:[0,1,1] op_sel_hi:[1,1,1]
    v_pk_fma_f32 v[212:213], v[212:213], v[78:79], v[78:79] op_sel:[0,1,1] op_sel_hi:[1,1,1]
    v_pk_fma_f32 v[214:215], v[214:215], v[78:79], v[78:79] op_sel:[0,1,1] op_sel_hi:[1,1,1]
    v_rcp_f32 v208, v208
    v_rcp_f32 v209, v209
    v_rcp_f32 v210, v210
    v_rcp_f32 v211, v211
    v_rcp_f32 v212, v212
    v_rcp_f32 v213, v213
    buffer_load_dwordx4 a[20:23], v17, s[40:43], s68 offen offset:1024 sc1
    v_rcp_f32 v214, v214
    v_rcp_f32 v215, v215
    v_pk_mul_f32 v[216:217], v[216:217], v[208:209]
    v_pk_mul_f32 v[218:219], v[218:219], v[210:211]
    v_pk_mul_f32 v[220:221], v[220:221], v[212:213]
    v_pk_mul_f32 v[222:223], v[222:223], v[214:215]
    v_cvt_pk_bf16_f32 v208, v216, v217
    v_cvt_pk_bf16_f32 v209, v218, v219
    v_cvt_pk_bf16_f32 v210, v220, v221
    v_cvt_pk_bf16_f32 v211, v222, v223
    buffer_load_dwordx4 a[24:27], v17, s[40:43], s68 offen offset:2048 sc1
    s_add_u32 s61, s58, 401408
    buffer_store_dwordx4 v[208:211], v17, s[40:43], s61 offen sc1
    s_add_u32 s68, s63, 7168
    buffer_load_dwordx4 a[28:31], v17, s[40:43], s68 offen offset:0 sc1
    s_mov_b32 s57, 0
    s_load_dword s57, s[26:27], s53 offset:128
    buffer_load_dwordx4 a[32:35], v17, s[40:43], s68 offen offset:1024 sc1
    buffer_load_dwordx4 a[36:39], v17, s[40:43], s68 offen offset:2048 sc1
    s_waitcnt vmcnt(11)
    v_mfma_f32_16x16x32_bf16 v[144:147], v[80:83], a[0:3], 0
    ds_read_b64_tr_b16 a[96:97], v7 offset:32768
    v_mfma_f32_16x16x32_bf16 v[148:151], v[84:87], a[0:3], 0
    buffer_load_dwordx4 a[40:43], v17, s[40:43], s68 offen offset:3072 sc1
    ds_read_b64_tr_b16 a[98:99], v7 offset:34816
    v_mfma_f32_16x16x32_bf16 v[152:155], v[88:91], a[0:3], 0
    ds_read_b64_tr_b16 a[100:101], v8 offset:32768
    ds_read_b64_tr_b16 a[102:103], v8 offset:34816
    v_mfma_f32_16x16x32_bf16 v[156:159], v[92:95], a[0:3], 0
    s_waitcnt vmcnt(10)
    ds_read_b64_tr_b16 a[104:105], v9 offset:32768
    v_mfma_f32_16x16x32_bf16 v[144:147], v[96:99], a[4:7], v[144:147]
    ds_read_b64_tr_b16 a[106:107], v9 offset:34816
    ds_read_b64_tr_b16 a[108:109], v10 offset:32768
    v_mfma_f32_16x16x32_bf16 v[148:151], v[100:103], a[4:7], v[148:151]
    s_add_u32 s68, s63, 11264
    buffer_load_dwordx4 a[44:47], v17, s[40:43], s68 offen offset:0 sc1
    v_mfma_f32_16x16x32_bf16 v[152:155], v[104:107], a[4:7], v[152:155]
    ds_read_b64_tr_b16 a[110:111], v10 offset:34816
    ds_read_b64_tr_b16 a[112:113], v7 offset:49152
    v_mfma_f32_16x16x32_bf16 v[156:159], v[108:111], a[4:7], v[156:159]
    s_waitcnt vmcnt(10)
    ds_read_b64_tr_b16 a[114:115], v7 offset:51200
    v_mfma_f32_16x16x32_bf16 v[144:147], v[112:115], a[8:11], v[144:147]
    ds_read_b64_tr_b16 a[116:117], v8 offset:49152
    ds_read_b64_tr_b16 a[118:119], v8 offset:51200
    v_mfma_f32_16x16x32_bf16 v[148:151], v[116:119], a[8:11], v[148:151]
    buffer_load_dwordx4 a[48:51], v17, s[40:43], s68 offen offset:1024 sc1
    ds_read_b64_tr_b16 a[120:121], v9 offset:49152
    v_mfma_f32_16x16x32_bf16 v[152:155], v[120:123], a[8:11], v[152:155]
    ds_read_b64_tr_b16 a[122:123], v9 offset:51200
    ds_read_b64_tr_b16 a[124:125], v10 offset:49152
    v_mfma_f32_16x16x32_bf16 v[156:159], v[124:127], a[8:11], v[156:159]
    s_waitcnt vmcnt(10)
    ds_read_b64_tr_b16 a[126:127], v10 offset:51200
    v_mfma_f32_16x16x32_bf16 v[144:147], v[128:131], a[12:15], v[144:147]
    ds_read_b64_tr_b16 a[128:129], v28 offset:0
    ds_read_b64_tr_b16 a[130:131], v28 offset:2048
    v_mfma_f32_16x16x32_bf16 v[148:151], v[132:135], a[12:15], v[148:151]
    buffer_load_dwordx4 a[52:55], v17, s[40:43], s68 offen offset:2048 sc1
    ds_read_b64_tr_b16 a[132:133], v29 offset:0
    v_mfma_f32_16x16x32_bf16 v[152:155], v[136:139], a[12:15], v[152:155]
    ds_read_b64_tr_b16 a[134:135], v29 offset:2048
    ds_read_b64_tr_b16 a[136:137], v30 offset:0
    v_mfma_f32_16x16x32_bf16 v[156:159], v[140:143], a[12:15], v[156:159]
    s_waitcnt vmcnt(10)
    ds_read_b64_tr_b16 a[138:139], v30 offset:2048
    v_mfma_f32_16x16x32_bf16 v[144:147], v[160:163], a[16:19], v[144:147]
    s_cmp_ge_u32 s57, 14
    s_cbranch_scc0 SL_q1
BK_q1:
    v_mfma_f32_16x16x32_bf16 v[148:151], v[164:167], a[16:19], v[148:151]
    s_add_u32 s68, s66, 57344
    buffer_load_dwordx4 a[0:3], v17, s[40:43], s68 offen offset:0 sc1
    s_waitcnt vmcnt(8)
    s_atomic_add s56, s[26:27], s52 offset:384
    v_mfma_f32_16x16x32_bf16 v[152:155], v[168:171], a[16:19], v[152:155]
    ds_read_b64_tr_b16 a[140:141], v31 offset:0
    ds_read_b64_tr_b16 a[142:143], v31 offset:2048
    v_mfma_f32_16x16x32_bf16 v[156:159], v[172:175], a[16:19], v[156:159]
    ds_read_b64_tr_b16 a[144:145], v7 offset:0
    v_mfma_f32_16x16x32_bf16 v[144:147], v[192:195], a[20:23], v[144:147]
    ds_read_b64_tr_b16 a[146:147], v7 offset:2048
    ds_read_b64_tr_b16 a[148:149], v8 offset:0
    v_mfma_f32_16x16x32_bf16 v[148:151], v[196:199], a[20:23], v[148:151]
    buffer_load_dwordx4 a[4:7], v17, s[40:43], s68 offen offset:1024 sc1
    ds_read_b64_tr_b16 a[150:151], v8 offset:2048
    v_mfma_f32_16x16x32_bf16 v[152:155], v[200:203], a[20:23], v[152:155]
    ds_read_b64_tr_b16 a[152:153], v9 offset:0
    ds_read_b64_tr_b16 a[154:155], v9 offset:2048
    v_mfma_f32_16x16x32_bf16 v[156:159], v[204:207], a[20:23], v[156:159]
    s_waitcnt lgkmcnt(15)
    ds_read_b64_tr_b16 a[156:157], v10 offset:0
    v_mfma_f32_16x16x32_bf16 v[144:147], a[96:99], a[24:27], v[144:147]
    ds_read_b64_tr_b16 a[158:159], v10 offset:2048
    ds_read_b64_tr_b16 a[160:161], v28 offset:16384
    v_mfma_f32_16x16x32_bf16 v[148:151], a[100:103], a[24:27], v[148:151]
    buffer_load_dwordx4 a[8:11], v17, s[40:43], s68 offen offset:2048 sc1
    ds_read_b64_tr_b16 a[162:163], v28 offset:18432
    v_mfma_f32_16x16x32_bf16 v[152:155], a[104:107], a[24:27], v[152:155]
    ds_read_b64_tr_b16 a[164:165], v29 offset:16384
    ds_read_b64_tr_b16 a[166:167], v29 offset:18432
    v_mfma_f32_16x16x32_bf16 v[156:159], a[108:111], a[24:27], v[156:159]
    s_waitcnt vmcnt(9) lgkmcnt(15)
    ds_read_b64_tr_b16 a[168:169], v30 offset:16384
    v_mfma_f32_16x16x32_bf16 v[144:147], a[112:115], a[28:31], v[144:147]
    ds_read_b64_tr_b16 a[170:171], v30 offset:18432
    ds_read_b64_tr_b16 a[172:173], v31 offset:16384
    v_mfma_f32_16x16x32_bf16 v[148:151], a[116:119], a[28:31], v[148:151]
    buffer_load_dwordx4 a[12:15], v17, s[40:43], s68 offen offset:3072 sc1
    ds_read_b64_tr_b16 a[174:175], v31 offset:18432
    v_mfma_f32_16x16x32_bf16 v[152:155], a[120:123], a[28:31], v[152:155]
    ds_read_b64_tr_b16 a[176:177], v28 offset:32768
    ds_read_b64_tr_b16 a[178:179], v28 offset:34816
    v_mfma_f32_16x16x32_bf16 v[156:159], a[124:127], a[28:31], v[156:159]
    s_waitcnt vmcnt(9) lgkmcnt(15)
    ds_read_b64_tr_b16 a[180:181], v29 offset:32768
    v_mfma_f32_16x16x32_bf16 v[144:147], a[128:131], a[32:35], v[144:147]
    ds_read_b64_tr_b16 a[182:183], v29 offset:34816
    ds_read_b64_tr_b16 a[184:185], v30 offset:32768
    v_mfma_f32_16x16x32_bf16 v[148:151], a[132:135], a[32:35], v[148:151]
    s_add_u32 s68, s66, 61440
    buffer_load_dwordx4 a[16:19], v17, s[40:43], s68 offen offset:0 sc1
    v_mfma_f32_16x16x32_bf16 v[152:155], a[136:139], a[32:35], v[152:155]
    ds_read_b64_tr_b16 a[186:187], v30 offset:34816
    ds_read_b64_tr_b16 a[188:189], v31 offset:32768
    v_mfma_f32_16x16x32_bf16 v[156:159], a[140:143], a[32:35], v[156:159]
    s_waitcnt vmcnt(9) lgkmcnt(15)
    ds_read_b64_tr_b16 a[190:191], v31 offset:34816
    v_mfma_f32_16x16x32_bf16 v[144:147], a[144:147], a[36:39], v[144:147]
    ds_read_b64_tr_b16 a[192:193], v7 offset:16384
    ds_read_b64_tr_b16 a[194:195], v7 offset:18432
    v_mfma_f32_16x16x32_bf16 v[148:151], a[148:151], a[36:39], v[148:151]
    buffer_load_dwordx4 a[20:23], v17, s[40:43], s68 offen offset:1024 sc1
    ds_read_b64_tr_b16 a[196:197], v8 offset:16384
    v_mfma_f32_16x16x32_bf16 v[152:155], a[152:155], a[36:39], v[152:155]
    ds_read_b64_tr_b16 a[198:199], v8 offset:18432
    ds_read_b64_tr_b16 a[200:201], v9 offset:16384
    v_mfma_f32_16x16x32_bf16 v[156:159], a[156:159], a[36:39], v[156:159]
    s_waitcnt vmcnt(9) lgkmcnt(13)
    ds_read_b64_tr_b16 a[202:203], v9 offset:18432
    v_mfma_f32_16x16x32_bf16 v[144:147], a[160:163], a[40:43], v[144:147]
    ds_read_b64_tr_b16 a[204:205], v10 offset:16384
    ds_read_b64_tr_b16 a[206:207], v10 offset:18432
    v_mfma_f32_16x16x32_bf16 v[148:151], a[164:167], a[40:43], v[148:151]
    buffer_load_dwordx4 a[24:27], v17, s[40:43], s68 offen offset:2048 sc1
    ds_read_b64_tr_b16 a[208:209], v28 offset:49152
    v_mfma_f32_16x16x32_bf16 v[152:155], a[168:171], a[40:43], v[152:155]
    ds_read_b64_tr_b16 a[210:211], v28 offset:51200
    ds_read_b64_tr_b16 a[212:213], v29 offset:49152
    v_mfma_f32_16x16x32_bf16 v[156:159], a[172:175], a[40:43], v[156:159]
    s_waitcnt vmcnt(9) lgkmcnt(11)
    ds_read_b64_tr_b16 a[214:215], v29 offset:51200
    v_mfma_f32_16x16x32_bf16 v[144:147], a[176:179], a[44:47], v[144:147]
    ds_read_b64_tr_b16 a[216:217], v30 offset:49152
    ds_read_b64_tr_b16 a[218:219], v30 offset:51200
    v_mfma_f32_16x16x32_bf16 v[148:151], a[180:183], a[44:47], v[148:151]
    s_add_u32 s68, s63, 64512
    buffer_load_dwordx4 a[28:31], v17, s[40:43], s68 offen offset:0 sc1
    v_mfma_f32_16x16x32_bf16 v[152:155], a[184:187], a[44:47], v[152:155]
    ds_read_b64_tr_b16 a[220:221], v31 offset:49152
    ds_read_b64_tr_b16 a[222:223], v31 offset:51200
    v_mfma_f32_16x16x32_bf16 v[156:159], a[188:191], a[44:47], v[156:159]
    s_waitcnt vmcnt(9) lgkmcnt(8)
    ds_read_b64 v[248:249], v20 offset:0
    v_mfma_f32_16x16x32_bf16 v[144:147], a[192:195], a[48:51], v[144:147]
    ds_read_b64 v[250:251], v20 offset:512
    ds_read_b64 v[252:253], v20 offset:1024
    v_mfma_f32_16x16x32_bf16 v[148:151], a[196:199], a[48:51], v[148:151]
    buffer_load_dwordx4 a[32:35], v17, s[40:43], s68 offen offset:1024 sc1
    ds_read_b64 v[254:255], v20 offset:1536
    ds_read_u8 v21, v0
    ds_read_u8 v21, v0
    ds_read_u8 v21, v0
    v_mfma_f32_16x16x32_bf16 v[152:155], a[200:203], a[48:51], v[152:155]
    v_mfma_f32_16x16x32_bf16 v[156:159], a[204:207], a[48:51], v[156:159]
    s_waitcnt vmcnt(9) lgkmcnt(4)
    v_mfma_f32_16x16x32_bf16 v[144:147], a[208:211], a[52:55], v[144:147]
    v_mfma_f32_16x16x32_bf16 v[148:151], a[212:215], a[52:55], v[148:151]
    buffer_load_dwordx4 a[36:39], v17, s[40:43], s68 offen offset:2048 sc1
    v_mfma_f32_16x16x32_bf16 v[152:155], a[216:219], a[52:55], v[152:155]
    s_mov_b32 s57, 0
    s_load_dword s57, s[26:27], s53 offset:256
    v_mfma_f32_16x16x32_bf16 v[156:159], a[220:223], a[52:55], v[156:159]
    s_waitcnt vmcnt(9)
    s_waitcnt lgkmcnt(3)
P2:
    v_mfma_f32_16x16x32_bf16 v[176:179], v[80:83], a[0:3], 0
    v_xor_b32 v1, 128, v33
    v_xor_b32 v2, 256, v33
    v_mfma_f32_16x16x32_bf16 v[180:183], v[84:87], a[0:3], 0
    buffer_load_dwordx4 a[40:43], v17, s[40:43], s68 offen offset:3072 sc1
    v_xor_b32 v3, 384, v33
    v_mfma_f32_16x16x32_bf16 v[184:187], v[88:91], a[0:3], 0
    v_add_f32 v52, 0x0, v39
    v_mul_f32 v52, s71, v52
    v_mfma_f32_16x16x32_bf16 v[188:191], v[92:95], a[0:3], 0
    s_waitcnt vmcnt(9)
    v_add_f32 v53, 0x3f800000, v39
    v_mul_f32 v53, s71, v53
    v_mfma_f32_16x16x32_bf16 v[176:179], v[96:99], a[4:7], v[176:179]
    v_add_f32 v54, 0x40000000, v39
    v_mul_f32 v54, s71, v54
    v_mfma_f32_16x16x32_bf16 v[180:183], v[100:103], a[4:7], v[180:183]
    s_add_u32 s68, s63, 68608
    buffer_load_dwordx4 a[44:47], v17, s[40:43], s68 offen offset:0 sc1
    v_mfma_f32_16x16x32_bf16 v[184:187], v[104:107], a[4:7], v[184:187]
    v_add_f32 v55, 0x40400000, v39
    v_mul_f32 v55, s71, v55
    v_mfma_f32_16x16x32_bf16 v[188:191], v[108:111], a[4:7], v[188:191]
    s_waitcnt vmcnt(9)
    v_mul_f32 v56, v38, v52
    v_mul_f32 v57, v38, v53
    v_mfma_f32_16x16x32_bf16 v[176:179], v[112:115], a[8:11], v[176:179]
    v_mul_f32 v58, v38, v54
    v_mul_f32 v59, v38, v55
    v_mfma_f32_16x16x32_bf16 v[180:183], v[116:119], a[8:11], v[180:183]
    buffer_load_dwordx4 a[48:51], v17, s[40:43], s68 offen offset:1024 sc1
    v_fract_f32 v56, v56
    v_mfma_f32_16x16x32_bf16 v[184:187], v[120:123], a[8:11], v[184:187]
    v_fract_f32 v57, v57
    v_fract_f32 v58, v58
    v_mfma_f32_16x16x32_bf16 v[188:191], v[124:127], a[8:11], v[188:191]
    s_waitcnt vmcnt(9)
    v_fract_f32 v59, v59
    v_add_f32 v38, 0x44000000, v38
    v_mfma_f32_16x16x32_bf16 v[176:179], v[128:131], a[12:15], v[176:179]
    v_cos_f32 v60, v56
    v_mfma_f32_16x16x32_bf16 v[180:183], v[132:135], a[12:15], v[180:183]
    buffer_load_dwordx4 a[52:55], v17, s[40:43], s68 offen offset:2048 sc1
    v_mfma_f32_16x16x32_bf16 v[184:187], v[136:139], a[12:15], v[184:187]
    v_sin_f32 v64, v56
    v_mfma_f32_16x16x32_bf16 v[188:191], v[140:143], a[12:15], v[188:191]
    s_waitcnt vmcnt(9)
    v_cos_f32 v61, v57
    v_mfma_f32_16x16x32_bf16 v[176:179], v[160:163], a[16:19], v[176:179]
    s_cmp_ge_u32 s57, 14
    s_cbranch_scc0 SL_q2
BK_q2:
    v_cvt_pk_bf16_f32 v68, v60, v64
    v_mfma_f32_16x16x32_bf16 v[180:183], v[164:167], a[16:19], v[180:183]
    s_add_u32 s68, s66, 114688
    buffer_load_dwordx4 a[0:3], v17, s[40:43], s68 offen offset:0 sc1
    v_mfma_f32_16x16x32_bf16 v[184:187], v[168:171], a[16:19], v[184:187]
    v_sin_f32 v65, v57
    v_mfma_f32_16x16x32_bf16 v[188:191], v[172:175], a[16:19], v[188:191]
    s_waitcnt vmcnt(9)
    v_cos_f32 v62, v58
    v_mfma_f32_16x16x32_bf16 v[176:179], v[192:195], a[20:23], v[176:179]
    v_sin_f32 v66, v58
    v_mfma_f32_16x16x32_bf16 v[180:183], v[196:199], a[20:23], v[180:183]
    buffer_load_dwordx4 a[4:7], v17, s[40:43], s68 offen offset:1024 sc1
    v_cvt_pk_bf16_f32 v69, v61, v65
    v_mfma_f32_16x16x32_bf16 v[184:187], v[200:203], a[20:23], v[184:187]
    v_cos_f32 v63, v59
    v_mfma_f32_16x16x32_bf16 v[188:191], v[204:207], a[20:23], v[188:191]
    s_waitcnt vmcnt(9)
    v_sin_f32 v67, v59
    v_mfma_f32_16x16x32_bf16 v[176:179], a[96:99], a[24:27], v[176:179]
    v_cvt_pk_bf16_f32 v70, v62, v66
    v_cvt_pk_bf16_f32 v71, v63, v67
    v_mfma_f32_16x16x32_bf16 v[180:183], a[100:103], a[24:27], v[180:183]
    buffer_load_dwordx4 a[8:11], v17, s[40:43], s68 offen offset:2048 sc1
    v_mul_f32 v56, v38, v52
    v_mfma_f32_16x16x32_bf16 v[184:187], a[104:107], a[24:27], v[184:187]
    v_mul_f32 v57, v38, v53
    v_mul_f32 v58, v38, v54
    v_mfma_f32_16x16x32_bf16 v[188:191], a[108:111], a[24:27], v[188:191]
    s_mov_b32 s65, 0
    s_load_dword s65, s[26:27], s74
    s_mov_b32 s0, 0
    s_load_dword s0, s[26:27], s1
    s_waitcnt vmcnt(9)
    v_mfma_f32_16x16x32_bf16 v[176:179], a[112:115], a[28:31], v[176:179]
    v_mul_f32 v59, v38, v55
    v_fract_f32 v56, v56
    v_mfma_f32_16x16x32_bf16 v[180:183], a[116:119], a[28:31], v[180:183]
    buffer_load_dwordx4 a[12:15], v17, s[40:43], s68 offen offset:3072 sc1
    v_fract_f32 v57, v57
    v_mfma_f32_16x16x32_bf16 v[184:187], a[120:123], a[28:31], v[184:187]
    v_fract_f32 v58, v58
    v_fract_f32 v59, v59
    v_mfma_f32_16x16x32_bf16 v[188:191], a[124:127], a[28:31], v[188:191]
    s_waitcnt vmcnt(9)
    v_cos_f32 v60, v56
    v_mfma_f32_16x16x32_bf16 v[176:179], a[128:131], a[32:35], v[176:179]
    v_sin_f32 v64, v56
    v_mfma_f32_16x16x32_bf16 v[180:183], a[132:135], a[32:35], v[180:183]
    s_add_u32 s68, s66, 118784
    buffer_load_dwordx4 a[16:19], v17, s[40:43], s68 offen offset:0 sc1
    v_mfma_f32_16x16x32_bf16 v[184:187], a[136:139], a[32:35], v[184:187]
    v_cos_f32 v61, v57
    v_mfma_f32_16x16x32_bf16 v[188:191], a[140:143], a[32:35], v[188:191]
    s_waitcnt vmcnt(9)
    v_sin_f32 v65, v57
    v_mfma_f32_16x16x32_bf16 v[176:179], a[144:147], a[36:39], v[176:179]
    v_cos_f32 v62, v58
    v_mfma_f32_16x16x32_bf16 v[180:183], a[148:151], a[36:39], v[180:183]
    buffer_load_dwordx4 a[20:23], v17, s[40:43], s68 offen offset:1024 sc1
    v_cvt_pk_bf16_f32 v72, v60, v64
    v_mfma_f32_16x16x32_bf16 v[184:187], a[152:155], a[36:39], v[184:187]
    v_sin_f32 v66, v58
    v_mfma_f32_16x16x32_bf16 v[188:191], a[156:159], a[36:39], v[188:191]
    s_waitcnt vmcnt(9)
    v_cos_f32 v63, v59
    v_mfma_f32_16x16x32_bf16 v[176:179], a[160:163], a[40:43], v[176:179]
    v_sin_f32 v67, v59
    v_mfma_f32_16x16x32_bf16 v[180:183], a[164:167], a[40:43], v[180:183]
    buffer_load_dwordx4 a[24:27], v17, s[40:43], s68 offen offset:2048 sc1
    v_cvt_pk_bf16_f32 v73, v61, v65
    v_mfma_f32_16x16x32_bf16 v[184:187], a[168:171], a[40:43], v[184:187]
    v_cvt_pk_bf16_f32 v74, v62, v66
    v_cvt_pk_bf16_f32 v75, v63, v67
    v_mfma_f32_16x16x32_bf16 v[188:191], a[172:175], a[40:43], v[188:191]
    s_waitcnt vmcnt(9)
    v_add_f32 v38, 0x44000000, v38
    v_mul_f32 v56, v38, v52
    v_mfma_f32_16x16x32_bf16 v[176:179], a[176:179], a[44:47], v[176:179]
    v_mul_f32 v57, v38, v53
    v_mul_f32 v58, v38, v54
    v_mfma_f32_16x16x32_bf16 v[180:183], a[180:183], a[44:47], v[180:183]
    s_add_u32 s68, s63, 121856
    buffer_load_dwordx4 a[28:31], v17, s[40:43], s68 offen offset:0 sc1
    v_mfma_f32_16x16x32_bf16 v[184:187], a[184:187], a[44:47], v[184:187]
    s_cmp_ge_u32 s65, 8
    s_cbranch_scc0 SL_a
BK_a:
    s_cmp_ge_u32 s0, 8
    s_cbranch_scc0 SL_ab
BK_ab:
    v_mfma_f32_16x16x32_bf16 v[188:191], a[188:191], a[44:47], v[188:191]
    s_mov_b32 m0, s59
    s_nop 0
    buffer_load_dwordx4 v32, s[40:43], s76 offen offset:0 sc1 lds
    s_waitcnt vmcnt(10)
    v_mfma_f32_16x16x32_bf16 v[176:179], a[192:195], a[48:51], v[176:179]
    v_mul_f32 v59, v38, v55
    v_fract_f32 v56, v56
    v_mfma_f32_16x16x32_bf16 v[180:183], a[196:199], a[48:51], v[180:183]
    buffer_load_dwordx4 a[32:35], v17, s[40:43], s68 offen offset:1024 sc1
    v_fract_f32 v57, v57
    v_mfma_f32_16x16x32_bf16 v[184:187], a[200:203], a[48:51], v[184:187]
    v_fract_f32 v58, v58
    v_fract_f32 v59, v59
    v_mfma_f32_16x16x32_bf16 v[188:191], a[204:207], a[48:51], v[188:191]
    buffer_load_dwordx4 v32, s[40:43], s77 offen offset:1024 sc1 lds
    s_waitcnt vmcnt(11)
    v_add_f32 v38, 0x44000000, v38
    v_mfma_f32_16x16x32_bf16 v[176:179], a[208:211], a[52:55], v[176:179]
    v_cos_f32 v60, v56
    v_mfma_f32_16x16x32_bf16 v[180:183], a[212:215], a[52:55], v[180:183]
    buffer_load_dwordx4 a[36:39], v17, s[40:43], s68 offen offset:2048 sc1
    v_mfma_f32_16x16x32_bf16 v[184:187], a[216:219], a[52:55], v[184:187]
    v_sin_f32 v64, v56
    v_mfma_f32_16x16x32_bf16 v[188:191], a[220:223], a[52:55], v[188:191]
    buffer_load_dwordx4 v32, s[40:43], s78 offen offset:2048 sc1 lds
    s_waitcnt vmcnt(12)
    v_cvt_pk_bf16_f32 v76, v60, v64
    v_mfma_f32_16x16x32_bf16 v[208:211], v[80:83], a[0:3], 0
    v_lshlrev_b32 v224, 16, v248
    v_and_b32 v225, 0xffff0000, v248
    v_mfma_f32_16x16x32_bf16 v[212:215], v[84:87], a[0:3], 0
    buffer_load_dwordx4 a[40:43], v17, s[40:43], s68 offen offset:3072 sc1
    v_lshlrev_b32 v226, 16, v249
    v_mfma_f32_16x16x32_bf16 v[216:219], v[88:91], a[0:3], 0
    s_mov_b32 s57, 0
    s_load_dword s57, s[26:27], s53 offset:384
    v_and_b32 v227, 0xffff0000, v249
    v_mfma_f32_16x16x32_bf16 v[220:223], v[92:95], a[0:3], 0
    buffer_load_dwordx4 v32, s[40:43], s79 offen offset:3072 sc1 lds
    s_waitcnt vmcnt(13)
    v_lshlrev_b32 v228, 16, v250
    v_mfma_f32_16x16x32_bf16 v[208:211], v[96:99], a[4:7], v[208:211]
    v_and_b32 v229, 0xffff0000, v250
    v_lshlrev_b32 v230, 16, v251
    v_mfma_f32_16x16x32_bf16 v[212:215], v[100:103], a[4:7], v[212:215]
    s_add_u32 s68, s63, 125952
    buffer_load_dwordx4 a[44:47], v17, s[40:43], s68 offen offset:0 sc1
    v_mfma_f32_16x16x32_bf16 v[216:219], v[104:107], a[4:7], v[216:219]
    v_and_b32 v231, 0xffff0000, v251
    v_lshlrev_b32 v232, 16, v252
    v_mfma_f32_16x16x32_bf16 v[220:223], v[108:111], a[4:7], v[220:223]
    s_waitcnt vmcnt(13)
    v_and_b32 v233, 0xffff0000, v252
    v_lshlrev_b32 v234, 16, v253
    v_mfma_f32_16x16x32_bf16 v[208:211], v[112:115], a[8:11], v[208:211]
    v_and_b32 v235, 0xffff0000, v253
    v_lshlrev_b32 v236, 16, v254
    v_mfma_f32_16x16x32_bf16 v[212:215], v[116:119], a[8:11], v[212:215]
    buffer_load_dwordx4 a[48:51], v17, s[40:43], s68 offen offset:1024 sc1
    v_and_b32 v237, 0xffff0000, v254
    v_mfma_f32_16x16x32_bf16 v[216:219], v[120:123], a[8:11], v[216:219]
    v_lshlrev_b32 v238, 16, v255
    v_and_b32 v239, 0xffff0000, v255
    v_mfma_f32_16x16x32_bf16 v[220:223], v[124:127], a[8:11], v[220:223]
    s_waitcnt vmcnt(13)
    v_cos_f32 v61, v57
    v_mfma_f32_16x16x32_bf16 v[208:211], v[128:131], a[12:15], v[208:211]
    v_sin_f32 v65, v57
    v_mfma_f32_16x16x32_bf16 v[212:215], v[132:135], a[12:15], v[212:215]
    buffer_load_dwordx4 a[52:55], v17, s[40:43], s68 offen offset:2048 sc1
    v_cvt_pk_bf16_f32 v77, v61, v65
    v_mfma_f32_16x16x32_bf16 v[216:219], v[136:139], a[12:15], v[216:219]
    v_cos_f32 v62, v58
    v_mfma_f32_16x16x32_bf16 v[220:223], v[140:143], a[12:15], v[220:223]
    s_waitcnt vmcnt(13)
    v_sin_f32 v66, v58
    v_mfma_f32_16x16x32_bf16 v[208:211], v[160:163], a[16:19], v[208:211]
    s_cmp_ge_u32 s57, 14
    s_cbranch_scc0 SL_q3
BK_q3:
    v_cvt_pk_bf16_f32 v78, v62, v66
    v_mfma_f32_16x16x32_bf16 v[212:215], v[164:167], a[16:19], v[212:215]
    s_add_u32 s68, s66, 172032
    buffer_load_dwordx4 a[0:3], v17, s[40:43], s68 offen offset:0 sc1
    v_mfma_f32_16x16x32_bf16 v[216:219], v[168:171], a[16:19], v[216:219]
    v_cos_f32 v63, v59
    v_mfma_f32_16x16x32_bf16 v[220:223], v[172:175], a[16:19], v[220:223]
    s_waitcnt vmcnt(13)
    v_sin_f32 v67, v59
    v_mfma_f32_16x16x32_bf16 v[208:211], v[192:195], a[20:23], v[208:211]
    v_cvt_pk_bf16_f32 v79, v63, v67
    v_mul_f32 v56, v38, v52
    v_mfma_f32_16x16x32_bf16 v[212:215], v[196:199], a[20:23], v[212:215]
    buffer_load_dwordx4 a[4:7], v17, s[40:43], s68 offen offset:1024 sc1
    v_mul_f32 v57, v38, v53
    v_mfma_f32_16x16x32_bf16 v[216:219], v[200:203], a[20:23], v[216:219]
    v_mul_f32 v58, v38, v54
    v_mul_f32 v59, v38, v55
    v_mfma_f32_16x16x32_bf16 v[220:223], v[204:207], a[20:23], v[220:223]
    s_waitcnt vmcnt(13)
    v_fract_f32 v56, v56
    v_fract_f32 v57, v57
    v_mfma_f32_16x16x32_bf16 v[208:211], a[96:99], a[24:27], v[208:211]
    v_fract_f32 v58, v58
    v_fract_f32 v59, v59
    v_mfma_f32_16x16x32_bf16 v[212:215], a[100:103], a[24:27], v[212:215]
    buffer_load_dwordx4 a[8:11], v17, s[40:43], s68 offen offset:2048 sc1
    v_mfma_f32_16x16x32_bf16 v[216:219], a[104:107], a[24:27], v[216:219]
    v_cos_f32 v60, v56
    v_mfma_f32_16x16x32_bf16 v[220:223], a[108:111], a[24:27], v[220:223]
    s_waitcnt vmcnt(13)
    v_sin_f32 v64, v56
    v_mfma_f32_16x16x32_bf16 v[208:211], a[112:115], a[28:31], v[208:211]
    v_cos_f32 v61, v57
    v_mfma_f32_16x16x32_bf16 v[212:215], a[116:119], a[28:31], v[212:215]
    buffer_load_dwordx4 a[12:15], v17, s[40:43], s68 offen offset:3072 sc1
    v_cvt_pk_bf16_f32 v48, v60, v64
    v_mfma_f32_16x16x32_bf16 v[216:219], a[120:123], a[28:31], v[216:219]
    v_sin_f32 v65, v57
    v_mfma_f32_16x16x32_bf16 v[220:223], a[124:127], a[28:31], v[220:223]
    s_waitcnt vmcnt(12)
    v_cos_f32 v62, v58
    v_mfma_f32_16x16x32_bf16 v[208:211], a[128:131], a[32:35], v[208:211]
    v_sin_f32 v66, v58
    v_cos_f32 v63, v59
    v_sin_f32 v67, v59
    v_cvt_pk_bf16_f32 v49, v61, v65
    v_cvt_pk_bf16_f32 v50, v62, v66
    v_cvt_pk_bf16_f32 v51, v63, v67
    v_mfma_f32_16x16x32_bf16 v[212:215], a[132:135], a[32:35], v[212:215]
    s_add_u32 s68, s66, 176128
    buffer_load_dwordx4 a[16:19], v17, s[40:43], s68 offen offset:0 sc1
    v_mfma_f32_16x16x32_bf16 v[216:219], a[136:139], a[32:35], v[216:219]
    v_mfma_f32_16x16x32_bf16 v[220:223], a[140:143], a[32:35], v[220:223]
    s_waitcnt vmcnt(11)
    v_mfma_f32_16x16x32_bf16 v[208:211], a[144:147], a[36:39], v[208:211]
    v_mfma_f32_16x16x32_bf16 v[212:215], a[148:151], a[36:39], v[212:215]
    buffer_load_dwordx4 a[20:23], v17, s[40:43], s68 offen offset:1024 sc1
    v_mfma_f32_16x16x32_bf16 v[216:219], a[152:155], a[36:39], v[216:219]
    s_waitcnt vmcnt(9)
    ds_read_b128 a[56:59], v33
    ds_read_b128 a[60:63], v1
    v_mfma_f32_16x16x32_bf16 v[220:223], a[156:159], a[36:39], v[220:223]
    v_mfma_f32_16x16x32_bf16 v[208:211], a[160:163], a[40:43], v[208:211]
    ds_read_b128 a[64:67], v2
    ds_read_b128 a[68:71], v3
    ds_read_u8 v21, v0
    v_mfma_f32_16x16x32_bf16 v[212:215], a[164:167], a[40:43], v[212:215]
    buffer_load_dwordx4 a[24:27], v17, s[40:43], s68 offen offset:2048 sc1
    v_mfma_f32_16x16x32_bf16 v[216:219], a[168:171], a[40:43], v[216:219]
    v_mfma_f32_16x16x32_bf16 v[220:223], a[172:175], a[40:43], v[220:223]
    s_waitcnt vmcnt(9)
    v_mfma_f32_16x16x32_bf16 v[208:211], a[176:179], a[44:47], v[208:211]
    v_mfma_f32_16x16x32_bf16 v[212:215], a[180:183], a[44:47], v[212:215]
    s_add_u32 s68, s63, 179200
    buffer_load_dwordx4 a[28:31], v17, s[40:43], s68 offen offset:0 sc1
    v_mfma_f32_16x16x32_bf16 v[216:219], a[184:187], a[44:47], v[216:219]
    v_mfma_f32_16x16x32_bf16 v[220:223], a[188:191], a[44:47], v[220:223]
    s_waitcnt lgkmcnt(1)
    v_mfma_f32_16x16x32_bf16 v[144:147], a[56:59], v[68:71], v[144:147]
    v_mfma_f32_16x16x32_bf16 v[148:151], a[60:63], v[68:71], v[148:151]
    buffer_load_dwordx4 a[32:35], v17, s[40:43], s68 offen offset:1024 sc1
    v_mfma_f32_16x16x32_bf16 v[152:155], a[64:67], v[68:71], v[152:155]
    v_mfma_f32_16x16x32_bf16 v[156:159], a[68:71], v[68:71], v[156:159]
    v_mfma_f32_16x16x32_bf16 v[176:179], a[56:59], v[72:75], v[176:179]
    v_mfma_f32_16x16x32_bf16 v[180:183], a[60:63], v[72:75], v[180:183]
    v_mfma_f32_16x16x32_bf16 v[184:187], a[64:67], v[72:75], v[184:187]
    v_mfma_f32_16x16x32_bf16 v[188:191], a[68:71], v[72:75], v[188:191]
    ds_write_b128 v34, v[144:147] offset:0
    v_mfma_f32_16x16x32_bf16 v[208:211], a[56:59], v[76:79], v[208:211]
    ds_write_b128 v35, v[148:151] offset:0
    v_mfma_f32_16x16x32_bf16 v[212:215], a[60:63], v[76:79], v[212:215]
    ds_write_b128 v34, v[152:155] offset:128
    v_mfma_f32_16x16x32_bf16 v[216:219], a[64:67], v[76:79], v[216:219]
    ds_write_b128 v35, v[156:159] offset:128
    v_mfma_f32_16x16x32_bf16 v[220:223], a[68:71], v[76:79], v[220:223]
    s_waitcnt vmcnt(10)
    ds_write_b128 v34, v[176:179] offset:16384
    v_mfma_f32_16x16x32_bf16 v[208:211], a[192:195], a[48:51], v[208:211]
    ds_write_b128 v35, v[180:183] offset:16384
    v_mfma_f32_16x16x32_bf16 v[212:215], a[196:199], a[48:51], v[212:215]
    buffer_load_dwordx4 a[36:39], v17, s[40:43], s68 offen offset:2048 sc1
    v_mfma_f32_16x16x32_bf16 v[216:219], a[200:203], a[48:51], v[216:219]
    ds_write_b128 v34, v[184:187] offset:16512
    v_mfma_f32_16x16x32_bf16 v[220:223], a[204:207], a[48:51], v[220:223]
    s_waitcnt vmcnt(10)
HG4:
    s_cbranch_execz HBG
    ds_write_b128 v35, v[188:191] offset:16512
    v_mfma_f32_16x16x32_bf16 v[208:211], a[208:211], a[52:55], v[208:211]
    v_mfma_f32_16x16x32_bf16 v[212:215], a[212:215], a[52:55], v[212:215]
    buffer_load_dwordx4 a[40:43], v17, s[40:43], s68 offen offset:3072 sc1
    v_mfma_f32_16x16x32_bf16 v[216:219], a[216:219], a[52:55], v[216:219]
    v_mfma_f32_16x16x32_bf16 v[220:223], a[220:223], a[52:55], v[220:223]
    s_waitcnt vmcnt(10)
    v_mfma_f32_16x16x32_bf16 v[40:43], v[80:83], a[0:3], 0
    v_mfma_f32_16x16x32_bf16 v[44:47], v[84:87], a[0:3], 0
    s_add_u32 s68, s63, 183296
    buffer_load_dwordx4 a[44:47], v17, s[40:43], s68 offen offset:0 sc1
    v_mfma_f32_16x16x32_bf16 v[24:27], v[88:91], a[0:3], 0
    v_mfma_f32_16x16x32_bf16 v[28:31], v[92:95], a[0:3], 0
    v_mfma_f32_16x16x32_bf16 v[40:43], a[56:59], v[48:51], v[40:43]
    ds_write_b128 v34, v[208:211] offset:32768
    v_mfma_f32_16x16x32_bf16 v[44:47], a[60:63], v[48:51], v[44:47]
    ds_write_b128 v35, v[212:215] offset:32768
    v_mfma_f32_16x16x32_bf16 v[24:27], a[64:67], v[48:51], v[24:27]
    ds_write_b128 v34, v[216:219] offset:32896
    v_mfma_f32_16x16x32_bf16 v[28:31], a[68:71], v[48:51], v[28:31]
    s_waitcnt vmcnt(10)
    ds_write_b128 v35, v[220:223] offset:32896
    ds_read_u8 v21, v0
    v_mfma_f32_16x16x32_bf16 v[40:43], v[96:99], a[4:7], v[40:43]
    v_mfma_f32_16x16x32_bf16 v[44:47], v[100:103], a[4:7], v[44:47]
    buffer_load_dwordx4 a[48:51], v17, s[40:43], s68 offen offset:1024 sc1
    v_mfma_f32_16x16x32_bf16 v[24:27], v[104:107], a[4:7], v[24:27]
    v_mfma_f32_16x16x32_bf16 v[28:31], v[108:111], a[4:7], v[28:31]
    s_waitcnt vmcnt(10)
    v_mfma_f32_16x16x32_bf16 v[40:43], v[112:115], a[8:11], v[40:43]
    v_mfma_f32_16x16x32_bf16 v[44:47], v[116:119], a[8:11], v[44:47]
    buffer_load_dwordx4 a[52:55], v17, s[40:43], s68 offen offset:2048 sc1
    s_waitcnt lgkmcnt(1)
    s_barrier
    v_mfma_f32_16x16x32_bf16 v[24:27], v[120:123], a[8:11], v[24:27]
    ds_read_b128 v[144:147], v36 offset:0
    ds_read_b128 v[148:151], v36 offset:4096
    v_mfma_f32_16x16x32_bf16 v[28:31], v[124:127], a[8:11], v[28:31]
    s_waitcnt vmcnt(10)
    ds_read_b128 v[152:155], v36 offset:8192
    v_mfma_f32_16x16x32_bf16 v[40:43], v[128:131], a[12:15], v[40:43]
    ds_read_b128 v[156:159], v36 offset:12288
    ds_read_b128 v[176:179], v36 offset:16384
    v_mfma_f32_16x16x32_bf16 v[44:47], v[132:135], a[12:15], v[44:47]
    ds_read_b128 v[180:183], v36 offset:20480
    ds_read_b128 v[184:187], v36 offset:24576
    v_mfma_f32_16x16x32_bf16 v[24:27], v[136:139], a[12:15], v[24:27]
    ds_read_b128 v[188:191], v36 offset:28672
    ds_read_b128 v[208:211], v36 offset:32768
    v_mfma_f32_16x16x32_bf16 v[28:31], v[140:143], a[12:15], v[28:31]
    s_waitcnt vmcnt(9)
    ds_read_b128 v[212:215], v36 offset:36864
    v_mfma_f32_16x16x32_bf16 v[40:43], v[160:163], a[16:19], v[40:43]
    ds_read_b128 v[216:219], v36 offset:40960
    ds_read_b128 v[220:223], v36 offset:45056
    v_mfma_f32_16x16x32_bf16 v[44:47], v[164:167], a[16:19], v[44:47]
    v_mfma_f32_16x16x32_bf16 v[24:27], v[168:171], a[16:19], v[24:27]
    s_waitcnt lgkmcnt(8)
    v_add_f32 v224, v224, v144
    v_add_f32 v225, v225, v145
    v_mfma_f32_16x16x32_bf16 v[28:31], v[172:175], a[16:19], v[28:31]
    s_waitcnt vmcnt(8)
    v_add_f32 v226, v226, v146
    v_add_f32 v227, v227, v147
    v_mfma_f32_16x16x32_bf16 v[40:43], v[192:195], a[20:23], v[40:43]
    v_add_f32 v224, v224, v148
    v_add_f32 v225, v225, v149
    v_mfma_f32_16x16x32_bf16 v[44:47], v[196:199], a[20:23], v[44:47]
    v_add_f32 v226, v226, v150
    v_add_f32 v227, v227, v151
    v_mfma_f32_16x16x32_bf16 v[24:27], v[200:203], a[20:23], v[24:27]
    v_add_f32 v224, v224, v152
    v_add_f32 v225, v225, v153
    v_mfma_f32_16x16x32_bf16 v[28:31], v[204:207], a[20:23], v[28:31]
    s_waitcnt vmcnt(7)
    v_add_f32 v226, v226, v154
    v_add_f32 v227, v227, v155
    v_mfma_f32_16x16x32_bf16 v[40:43], a[96:99], a[24:27], v[40:43]
    v_add_f32 v224, v224, v156
    v_add_f32 v225, v225, v157
    v_mfma_f32_16x16x32_bf16 v[44:47], a[100:103], a[24:27], v[44:47]
    v_add_f32 v226, v226, v158
    v_add_f32 v227, v227, v159
    v_mfma_f32_16x16x32_bf16 v[24:27], a[104:107], a[24:27], v[24:27]
    v_cvt_pk_bf16_f32 v248, v224, v225
    v_cvt_pk_bf16_f32 v249, v226, v227
    v_mfma_f32_16x16x32_bf16 v[28:31], a[108:111], a[24:27], v[28:31]
    s_waitcnt vmcnt(6)
    buffer_store_dwordx2 v[248:249], v37, s[48:51], s80 offen sc1
    v_mfma_f32_16x16x32_bf16 v[40:43], a[112:115], a[28:31], v[40:43]
    s_waitcnt lgkmcnt(4)
    v_add_f32 v228, v228, v176
    v_add_f32 v229, v229, v177
    v_mfma_f32_16x16x32_bf16 v[44:47], a[116:119], a[28:31], v[44:47]
    v_add_f32 v230, v230, v178
    v_add_f32 v231, v231, v179
    v_mfma_f32_16x16x32_bf16 v[24:27], a[120:123], a[28:31], v[24:27]
    v_add_f32 v228, v228, v180
    v_add_f32 v229, v229, v181
    v_mfma_f32_16x16x32_bf16 v[28:31], a[124:127], a[28:31], v[28:31]
    s_waitcnt vmcnt(6)
    v_add_f32 v230, v230, v182
    v_add_f32 v231, v231, v183
    v_mfma_f32_16x16x32_bf16 v[40:43], a[128:131], a[32:35], v[40:43]
    v_add_f32 v228, v228, v184
    v_add_f32 v229, v229, v185
    v_mfma_f32_16x16x32_bf16 v[44:47], a[132:135], a[32:35], v[44:47]
    v_add_f32 v230, v230, v186
    v_add_f32 v231, v231, v187
    v_mfma_f32_16x16x32_bf16 v[24:27], a[136:139], a[32:35], v[24:27]
    v_add_f32 v228, v228, v188
    v_add_f32 v229, v229, v189
    v_mfma_f32_16x16x32_bf16 v[28:31], a[140:143], a[32:35], v[28:31]
    s_waitcnt vmcnt(5)
    v_add_f32 v230, v230, v190
    v_add_f32 v231, v231, v191
    v_mfma_f32_16x16x32_bf16 v[40:43], a[144:147], a[36:39], v[40:43]
    v_cvt_pk_bf16_f32 v250, v228, v229
    v_cvt_pk_bf16_f32 v251, v230, v231
    v_mfma_f32_16x16x32_bf16 v[44:47], a[148:151], a[36:39], v[44:47]
    buffer_store_dwordx2 v[250:251], v37, s[48:51], s81 offen sc1
    v_mfma_f32_16x16x32_bf16 v[24:27], a[152:155], a[36:39], v[24:27]
    s_waitcnt lgkmcnt(0)
    v_add_f32 v232, v232, v208
    v_add_f32 v233, v233, v209
    v_mfma_f32_16x16x32_bf16 v[28:31], a[156:159], a[36:39], v[28:31]
    s_waitcnt vmcnt(5)
    v_add_f32 v234, v234, v210
    v_add_f32 v235, v235, v211
    v_mfma_f32_16x16x32_bf16 v[40:43], a[160:163], a[40:43], v[40:43]
    v_add_f32 v232, v232, v212
    v_add_f32 v233, v233, v213
    v_mfma_f32_16x16x32_bf16 v[44:47], a[164:167], a[40:43], v[44:47]
    v_add_f32 v234, v234, v214
    v_add_f32 v235, v235, v215
    v_mfma_f32_16x16x32_bf16 v[24:27], a[168:171], a[40:43], v[24:27]
    v_add_f32 v232, v232, v216
    v_add_f32 v233, v233, v217
    v_mfma_f32_16x16x32_bf16 v[28:31], a[172:175], a[40:43], v[28:31]
    s_waitcnt vmcnt(4)
    v_add_f32 v234, v234, v218
    v_add_f32 v235, v235, v219
    v_mfma_f32_16x16x32_bf16 v[40:43], a[176:179], a[44:47], v[40:43]
    v_add_f32 v232, v232, v220
    v_add_f32 v233, v233, v221
    v_mfma_f32_16x16x32_bf16 v[44:47], a[180:183], a[44:47], v[44:47]
    v_add_f32 v234, v234, v222
    v_add_f32 v235, v235, v223
    v_mfma_f32_16x16x32_bf16 v[24:27], a[184:187], a[44:47], v[24:27]
    v_cvt_pk_bf16_f32 v252, v232, v233
    v_cvt_pk_bf16_f32 v253, v234, v235
    v_mfma_f32_16x16x32_bf16 v[28:31], a[188:191], a[44:47], v[28:31]
    s_waitcnt vmcnt(3)
    buffer_store_dwordx2 v[252:253], v37, s[48:51], s82 offen sc1
    v_mfma_f32_16x16x32_bf16 v[40:43], a[192:195], a[48:51], v[40:43]
    v_mfma_f32_16x16x32_bf16 v[44:47], a[196:199], a[48:51], v[44:47]
    v_mfma_f32_16x16x32_bf16 v[24:27], a[200:203], a[48:51], v[24:27]
    v_mfma_f32_16x16x32_bf16 v[28:31], a[204:207], a[48:51], v[28:31]
    s_waitcnt vmcnt(3)
    v_mfma_f32_16x16x32_bf16 v[40:43], a[208:211], a[52:55], v[40:43]
    v_mfma_f32_16x16x32_bf16 v[44:47], a[212:215], a[52:55], v[44:47]
    v_mfma_f32_16x16x32_bf16 v[24:27], a[216:219], a[52:55], v[24:27]
    v_mfma_f32_16x16x32_bf16 v[28:31], a[220:223], a[52:55], v[28:31]
    s_nop 4
    ds_write_b128 v34, v[40:43] offset:49152
    ds_write_b128 v35, v[44:47] offset:49152
    ds_write_b128 v34, v[24:27] offset:49280
    ds_write_b128 v35, v[28:31] offset:49280
    s_waitcnt lgkmcnt(0)
    s_barrier
    ds_read_b128 v[40:43], v36 offset:49152
    ds_read_b128 v[44:47], v36 offset:53248
    ds_read_b128 v[24:27], v36 offset:57344
    ds_read_b128 v[28:31], v36 offset:61440
    s_waitcnt lgkmcnt(3)
    v_pk_add_f32 v[236:237], v[236:237], v[40:41]
    v_pk_add_f32 v[238:239], v[238:239], v[42:43]
    s_waitcnt lgkmcnt(2)
    v_pk_add_f32 v[236:237], v[236:237], v[44:45]
    v_pk_add_f32 v[238:239], v[238:239], v[46:47]
    s_waitcnt lgkmcnt(1)
    v_pk_add_f32 v[236:237], v[236:237], v[24:25]
    v_pk_add_f32 v[238:239], v[238:239], v[26:27]
    s_waitcnt lgkmcnt(0)
    v_pk_add_f32 v[236:237], v[236:237], v[28:29]
    v_pk_add_f32 v[238:239], v[238:239], v[30:31]
    v_cvt_pk_bf16_f32 v254, v236, v237
    v_cvt_pk_bf16_f32 v255, v238, v239
    buffer_store_dwordx2 v[254:255], v37, s[48:51], s83 offen sc1
    s_endpgm
    .p2align 12
DMAIN:
HD0:
    s_cbranch_execz HBD
    s_mov_b32 s44, s20
    s_mov_b32 s45, s21
    s_mov_b32 s46, 0x1c0000
    s_mov_b32 s47, 0x20000
    s_and_b32 s54, s2, 7
    s_lshl_b32 s62, s54, 2
    s_bfe_u32 s54, s2, 0x20003
    s_add_u32 s62, s62, s54
    s_lshr_b32 s63, s2, 5
    s_bfe_u32 s54, s2, 0x10001
    s_or_b32 s54, s54, 4
    s_xor_b32 s63, s63, s54
    s_lshl_b32 s54, s3, 15
    s_lshl_b32 s55, s63, 7
    s_add_u32 s64, s54, s55
    s_lshl_b32 s54, s62, 4
    s_add_u32 s54, s54, s3
    s_mul_i32 s66, s54, 14336
    s_mov_b32 s48, s22
    s_mov_b32 s49, s23
    s_mov_b32 s50, 0x200000
    s_mov_b32 s51, 0x20000
    s_lshr_b32 s70, s63, 2
    s_lshl_b32 s71, s70, 31
    s_xor_b32 s71, s71, 0xba000000
    s_mul_i32 s54, s70, 7
    s_xor_b32 s69, s63, s54
    s_lshl_b32 s69, s69, 5
    s_lshl_b32 s55, s70, 1
    s_sub_u32 s55, 1, s55
    s_mul_i32 s54, s62, s55
    s_and_b32 s54, s54, 31
    s_lshl_b32 s54, s54, 16
    s_lshl_b32 s55, s3, 14
    s_add_u32 s54, s54, s55
    s_add_u32 s76, s54, 8388608
    s_add_u32 s77, s54, 8391680
    s_add_u32 s78, s54, 8394752
    s_add_u32 s79, s54, 8397824
    s_lshl_b32 s54, s3, 17
    s_lshl_b32 s55, s62, 10
    s_add_u32 s54, s54, s55
    s_lshl_b32 s55, s63, 7
    s_add_u32 s80, s54, s55
    s_add_u32 s81, s80, 524288
    s_add_u32 s82, s80, 1048576
    s_add_u32 s83, s80, 1572864
    s_lshr_b32 s54, s62, 1
    s_lshl_b32 s54, s54, 2
    s_add_u32 s54, s54, s3
    s_mul_i32 s54, s54, 640
    s_add_u32 s53, s54, 12582912
    s_lshl_b32 s54, s3, 9
    s_lshl_b32 s55, s69, 2
    s_add_u32 s54, s54, s55
    s_add_u32 s74, s54, 12623872
    s_min_u32 s55, s55, 128
    s_lshl_b32 s54, s70, 7
    s_andn2_b32 s55, s55, s54
    s_sub_u32 s1, s74, s55
    v_lshrrev_b32 v42, 3, v0
    v_and_b32 v43, 7, v0
    v_and_b32 v24, 6, v42
    v_xor_b32 v43, v43, v24
    v_lshlrev_b32 v43, 4, v43
    v_lshl_add_u32 v24, v42, 10, v43
    v_add_u32 v25, 7168, v24
    v_add_u32 v26, 14336, v24
    v_add_u32 v27, 21504, v24
    v_lshrrev_b32 v43, 2, v0
    v_lshlrev_b32 v28, 7, v43
    v_bfe_u32 v43, v0, 3, 2
    v_lshl_add_u32 v28, v43, 5, v28
    v_and_b32 v43, 3, v0
    v_lshl_add_u32 v28, v43, 3, v28
    v_add_u32 v28, s59, v28
    v_xor_b32 v29, 32, v28
    v_xor_b32 v30, 64, v28
    v_xor_b32 v31, 96, v28
    v_add_u32 v7, 98304, v28
    v_add_u32 v8, 98304, v29
    v_add_u32 v9, 98304, v30
    v_add_u32 v10, 98304, v31
    v_and_b32 v38, 7, v0
    v_lshlrev_b32 v19, 4, v38
    v_bfe_u32 v38, v0, 3, 2
    v_lshl_add_u32 v19, v38, 15, v19
    v_lshrrev_b32 v38, 5, v0
    v_lshl_add_u32 v19, v38, 19, v19
    s_lshl_b32 s54, s3, 11
    s_add_u32 s54, s54, 16384
    v_lshl_add_u32 v20, v0, 3, s54
    v_and_b32 v38, 15, v0
    v_lshlrev_b32 v17, 4, v0
    v_lshrrev_b32 v42, 4, v0
    v_lshrrev_b32 v32, 5, v0
    s_xor_b32 s54, s70, 1
    v_and_b32 v39, s54, v32
    v_sub_u32 v39, s69, v39
    v_and_b32 v33, 31, v0
    v_add_u32 v39, v39, v33
    v_bfe_u32 v39, v39, 0, 26
    v_lshlrev_b32 v32, 11, v32
    v_lshl_add_u32 v32, v39, 4, v32
    s_mul_i32 s54, s70, 31
    s_or_b32 s54, s54, 32
    v_lshrrev_b32 v39, 1, v38
    buffer_load_dwordx4 v[168:171], v88, s[28:31], s86 offen offset:256
    v_and_b32 v33, 1, v0
    v_lshl_add_u32 v39, v33, 5, v39
    v_xor_b32 v39, s54, v39
    v_lshlrev_b32 v39, 4, v39
    v_lshl_add_u32 v39, v42, 10, v39
    v_add_u32 v33, s59, v39
    v_lshlrev_b32 v39, 3, v38
    v_lshl_add_u32 v37, v42, 15, v39
    v_and_b32 v39, 7, v0
    v_xor_b32 v39, v39, v42
    v_lshlrev_b32 v39, 4, v39
    v_lshl_add_u32 v39, v38, 8, v39
    v_add_u32 v39, 98304, v39
    v_add_u32 v34, s59, v39
    v_xor_b32 v35, 64, v34
    v_lshl_add_u32 v39, s3, 2, v42
    buffer_load_dwordx4 v[172:175], v88, s[28:31], s86 offen offset:384
    v_and_b32 v36, 7, v39
    v_xor_b32 v36, v36, v38
    v_lshlrev_b32 v36, 4, v36
    v_lshl_add_u32 v36, v39, 8, v36
    v_add_u32 v36, 98304, v36
    v_lshl_add_u32 v38, v38, 5, s62
    v_cvt_f32_u32 v38, v38
    v_lshlrev_b32 v39, 2, v39
    v_cvt_f32_u32 v39, v39
    s_and_b32 s54, s63, 1
    s_mul_i32 s55, s54, 917504
    s_mul_i32 s54, s54, 7168
    s_sub_u32 s62, s64, s55
    s_add_u32 s64, s64, s55
    s_sub_u32 s63, s66, s54
    s_add_u32 s66, s66, s54
    buffer_load_dwordx4 v[176:179], v88, s[28:31], s86 offen offset:512
    s_waitcnt vmcnt(12)
    s_cmp_lg_u32 s3, 0
    s_cbranch_scc1 NOCLR2
    s_atomic_add s58, s[24:25], 0
NOCLR2:
    v_mov_b32 v42, 0
    v_mov_b32 v43, 0
    v_dot2c_f32_bf16 v42, s56, v128
    v_dot2c_f32_bf16 v43, v128, v128
    v_dot2c_f32_bf16 v42, s56, v129
    v_dot2c_f32_bf16 v43, v129, v129
    v_dot2c_f32_bf16 v42, s56, v130
    v_dot2c_f32_bf16 v43, v130, v130
    v_dot2c_f32_bf16 v42, s56, v131
    v_dot2c_f32_bf16 v43, v131, v131
    buffer_load_dwordx4 v[180:183], v88, s[28:31], s86 offen offset:640
    s_waitcnt vmcnt(12)
    v_dot2c_f32_bf16 v42, s56, v132
    v_dot2c_f32_bf16 v43, v132, v132
    v_dot2c_f32_bf16 v42, s56, v133
    v_dot2c_f32_bf16 v43, v133, v133
    v_dot2c_f32_bf16 v42, s56, v134
    v_dot2c_f32_bf16 v43, v134, v134
    v_dot2c_f32_bf16 v42, s56, v135
    v_dot2c_f32_bf16 v43, v135, v135
    buffer_load_dwordx4 v[184:187], v88, s[28:31], s86 offen offset:768
    s_waitcnt vmcnt(12)
    v_dot2c_f32_bf16 v42, s56, v136
    v_dot2c_f32_bf16 v43, v136, v136
    v_dot2c_f32_bf16 v42, s56, v137
    v_dot2c_f32_bf16 v43, v137, v137
    v_dot2c_f32_bf16 v42, s56, v138
    v_dot2c_f32_bf16 v43, v138, v138
    v_dot2c_f32_bf16 v42, s56, v139
    v_dot2c_f32_bf16 v43, v139, v139
    buffer_load_dwordx4 v[188:191], v88, s[28:31], s86 offen offset:896
    s_waitcnt vmcnt(12)
    v_dot2c_f32_bf16 v42, s56, v140
    v_dot2c_f32_bf16 v43, v140, v140
    v_dot2c_f32_bf16 v42, s56, v141
    v_dot2c_f32_bf16 v43, v141, v141
    v_dot2c_f32_bf16 v42, s56, v142
    v_dot2c_f32_bf16 v43, v142, v142
    v_dot2c_f32_bf16 v42, s56, v143
    v_dot2c_f32_bf16 v43, v143, v143
    s_xor_b32 s86, s86, 1572864
    buffer_load_dwordx4 v[192:195], v88, s[28:31], s86 offen offset:0
    s_waitcnt vmcnt(12)
    v_dot2c_f32_bf16 v42, s56, v144
    v_dot2c_f32_bf16 v43, v144, v144
    v_dot2c_f32_bf16 v42, s56, v145
    v_dot2c_f32_bf16 v43, v145, v145
    v_dot2c_f32_bf16 v42, s56, v146
    v_dot2c_f32_bf16 v43, v146, v146
    v_dot2c_f32_bf16 v42, s56, v147
    v_dot2c_f32_bf16 v43, v147, v147
    buffer_load_dwordx4 v[196:199], v88, s[28:31], s86 offen offset:128
    s_waitcnt vmcnt(12)
    v_dot2c_f32_bf16 v42, s56, v148
    v_dot2c_f32_bf16 v43, v148, v148
    v_dot2c_f32_bf16 v42, s56, v149
    v_dot2c_f32_bf16 v43, v149, v149
    v_dot2c_f32_bf16 v42, s56, v150
    v_dot2c_f32_bf16 v43, v150, v150
    v_dot2c_f32_bf16 v42, s56, v151
    v_dot2c_f32_bf16 v43, v151, v151
    buffer_load_dwordx4 v[200:203], v88, s[28:31], s86 offen offset:256
    s_waitcnt vmcnt(12)
    v_dot2c_f32_bf16 v42, s56, v152
    v_dot2c_f32_bf16 v43, v152, v152
    v_dot2c_f32_bf16 v42, s56, v153
    v_dot2c_f32_bf16 v43, v153, v153
    v_dot2c_f32_bf16 v42, s56, v154
    v_dot2c_f32_bf16 v43, v154, v154
    v_dot2c_f32_bf16 v42, s56, v155
    v_dot2c_f32_bf16 v43, v155, v155
    buffer_load_dwordx4 v[204:207], v88, s[28:31], s86 offen offset:384
    s_waitcnt vmcnt(12)
    v_dot2c_f32_bf16 v42, s56, v156
    v_dot2c_f32_bf16 v43, v156, v156
    v_dot2c_f32_bf16 v42, s56, v157
    v_dot2c_f32_bf16 v43, v157, v157
    v_dot2c_f32_bf16 v42, s56, v158
    v_dot2c_f32_bf16 v43, v158, v158
    v_dot2c_f32_bf16 v42, s56, v159
    v_dot2c_f32_bf16 v43, v159, v159
    buffer_load_dwordx4 v[208:211], v88, s[28:31], s86 offen offset:512
    s_nop 0
    v_add_f32_dpp v42, v42, v42 quad_perm:[1,0,3,2] row_mask:0xf bank_mask:0xf
    v_add_f32_dpp v43, v43, v43 quad_perm:[1,0,3,2] row_mask:0xf bank_mask:0xf
    s_nop 0
    v_add_f32_dpp v42, v42, v42 quad_perm:[2,3,0,1] row_mask:0xf bank_mask:0xf
    v_add_f32_dpp v43, v43, v43 quad_perm:[2,3,0,1] row_mask:0xf bank_mask:0xf
    s_nop 0
    v_add_f32_dpp v42, v42, v42 row_half_mirror row_mask:0xf bank_mask:0xf
    v_add_f32_dpp v43, v43, v43 row_half_mirror row_mask:0xf bank_mask:0xf
    v_mul_f32 v42, 0x3b000000, v42
    v_mul_f32 v43, 0x3b000000, v43
    v_fma_f32 v43, -v42, v42, v43
    v_max_f32 v43, 0, v43
    v_add_f32 v43, 0x3727c5ac, v43
    v_rsq_f32 v44, v43
    v_mul_f32 v47, s97, v42
    v_cvt_pk_bf16_f32 v45, v44, 0
    v_lshlrev_b32 v46, 16, v45
    v_xor_b32 v48, s96, v45
    v_mul_f32 v47, v47, v46
    v_lshlrev_b32 v49, 16, v48
    buffer_load_dwordx4 v[212:215], v88, s[28:31], s86 offen offset:640
    v_dot2_f32_bf16 v58, v128, v45, v47
    v_dot2_f32_bf16 v59, v128, v46, v47
    v_mov_b32 v50, 0
    v_dot2_f32_bf16 v58, v144, v48, v58
    v_mov_b32 v51, 0
    v_dot2_f32_bf16 v59, v144, v49, v59
    s_waitcnt vmcnt(13)
    v_dot2c_f32_bf16 v50, s56, v160
    v_dot2_f32_bf16 v60, v129, v45, v47
    v_dot2_f32_bf16 v61, v129, v46, v47
    v_dot2c_f32_bf16 v51, v160, v160
    v_dot2_f32_bf16 v60, v145, v48, v60
    v_dot2c_f32_bf16 v50, s56, v161
    v_dot2_f32_bf16 v61, v145, v49, v61
    v_dot2c_f32_bf16 v51, v161, v161
    v_cvt_pk_bf16_f32 v64, v58, v59
    v_dot2_f32_bf16 v58, v130, v45, v47
    v_dot2c_f32_bf16 v50, s56, v162
    v_dot2_f32_bf16 v59, v130, v46, v47
    v_dot2c_f32_bf16 v51, v162, v162
    v_dot2_f32_bf16 v58, v146, v48, v58
    v_dot2c_f32_bf16 v50, s56, v163
    buffer_load_dwordx4 v[216:219], v88, s[28:31], s86 offen offset:768
    v_dot2_f32_bf16 v59, v146, v49, v59
    v_cvt_pk_bf16_f32 v65, v60, v61
    v_dot2c_f32_bf16 v51, v163, v163
    v_dot2_f32_bf16 v60, v131, v45, v47
    s_waitcnt vmcnt(13)
    v_dot2c_f32_bf16 v50, s56, v164
    v_dot2_f32_bf16 v61, v131, v46, v47
    v_dot2c_f32_bf16 v51, v164, v164
    v_dot2_f32_bf16 v60, v147, v48, v60
    v_dot2_f32_bf16 v61, v147, v49, v61
    v_dot2c_f32_bf16 v50, s56, v165
    v_cvt_pk_bf16_f32 v66, v58, v59
    v_dot2c_f32_bf16 v51, v165, v165
    v_dot2_f32_bf16 v58, v132, v45, v47
    v_dot2c_f32_bf16 v50, s56, v166
    v_dot2_f32_bf16 v59, v132, v46, v47
    v_dot2_f32_bf16 v58, v148, v48, v58
    v_dot2c_f32_bf16 v51, v166, v166
    v_dot2_f32_bf16 v59, v148, v49, v59
    v_dot2c_f32_bf16 v50, s56, v167
    v_cvt_pk_bf16_f32 v67, v60, v61
    v_dot2c_f32_bf16 v51, v167, v167
    buffer_load_dwordx4 v[220:223], v88, s[28:31], s86 offen offset:896
    ds_write_b128 v5, v[64:67] offset:0
    v_dot2_f32_bf16 v60, v133, v45, v47
    s_waitcnt vmcnt(13)
    v_dot2c_f32_bf16 v50, s56, v168
    v_dot2_f32_bf16 v61, v133, v46, v47
    v_dot2c_f32_bf16 v51, v168, v168
    v_dot2_f32_bf16 v60, v149, v48, v60
    v_dot2c_f32_bf16 v50, s56, v169
    v_dot2_f32_bf16 v61, v149, v49, v61
    v_dot2c_f32_bf16 v51, v169, v169
    v_cvt_pk_bf16_f32 v68, v58, v59
    v_dot2c_f32_bf16 v50, s56, v170
    v_dot2c_f32_bf16 v51, v170, v170
    v_dot2_f32_bf16 v58, v134, v45, v47
    v_dot2c_f32_bf16 v50, s56, v171
    v_dot2_f32_bf16 v59, v134, v46, v47
    v_dot2c_f32_bf16 v51, v171, v171
    s_xor_b32 s86, s86, 524288
    buffer_load_dwordx4 v[224:227], v88, s[28:31], s86 offen offset:0
    v_dot2_f32_bf16 v58, v150, v48, v58
    s_waitcnt vmcnt(13)
    v_dot2c_f32_bf16 v50, s56, v172
    v_dot2_f32_bf16 v59, v150, v49, v59
    v_dot2c_f32_bf16 v51, v172, v172
    v_cvt_pk_bf16_f32 v69, v60, v61
    v_dot2c_f32_bf16 v50, s56, v173
    v_dot2c_f32_bf16 v51, v173, v173
    v_dot2_f32_bf16 v60, v135, v45, v47
    v_dot2c_f32_bf16 v50, s56, v174
    v_dot2_f32_bf16 v61, v135, v46, v47
    v_dot2c_f32_bf16 v51, v174, v174
    v_dot2_f32_bf16 v60, v151, v48, v60
    v_dot2c_f32_bf16 v50, s56, v175
    v_dot2_f32_bf16 v61, v151, v49, v61
    v_dot2c_f32_bf16 v51, v175, v175
    buffer_load_dwordx4 v[228:231], v88, s[28:31], s86 offen offset:128
    v_cvt_pk_bf16_f32 v70, v58, v59
    s_waitcnt vmcnt(13)
    v_dot2c_f32_bf16 v50, s56, v176
    v_dot2c_f32_bf16 v51, v176, v176
    v_dot2_f32_bf16 v58, v136, v45, v47
    v_dot2c_f32_bf16 v50, s56, v177
    v_dot2_f32_bf16 v59, v136, v46, v47
    v_dot2c_f32_bf16 v51, v177, v177
    v_dot2_f32_bf16 v58, v152, v48, v58
    v_dot2c_f32_bf16 v50, s56, v178
    v_dot2_f32_bf16 v59, v152, v49, v59
    v_dot2c_f32_bf16 v51, v178, v178
    v_cvt_pk_bf16_f32 v71, v60, v61
    v_dot2c_f32_bf16 v50, s56, v179
    v_dot2c_f32_bf16 v51, v179, v179
    buffer_load_dwordx4 v[232:235], v88, s[28:31], s86 offen offset:256
    ds_write_b128 v5, v[68:71] offset:2048
    v_dot2_f32_bf16 v60, v137, v45, v47
    s_waitcnt vmcnt(13)
    v_dot2c_f32_bf16 v50, s56, v180
    v_dot2_f32_bf16 v61, v137, v46, v47
    v_dot2c_f32_bf16 v51, v180, v180
    v_dot2_f32_bf16 v60, v153, v48, v60
    v_dot2c_f32_bf16 v50, s56, v181
    v_dot2_f32_bf16 v61, v153, v49, v61
    v_dot2c_f32_bf16 v51, v181, v181
    v_cvt_pk_bf16_f32 v64, v58, v59
    v_dot2c_f32_bf16 v50, s56, v182
    v_dot2c_f32_bf16 v51, v182, v182
    v_dot2_f32_bf16 v58, v138, v45, v47
    v_dot2c_f32_bf16 v50, s56, v183
    v_dot2_f32_bf16 v59, v138, v46, v47
    v_dot2c_f32_bf16 v51, v183, v183
    buffer_load_dwordx4 v[236:239], v88, s[28:31], s86 offen offset:384
    v_dot2_f32_bf16 v58, v154, v48, v58
    s_waitcnt vmcnt(13)
    v_dot2c_f32_bf16 v50, s56, v184
    v_dot2_f32_bf16 v59, v154, v49, v59
    v_dot2c_f32_bf16 v51, v184, v184
    v_cvt_pk_bf16_f32 v65, v60, v61
    v_dot2c_f32_bf16 v50, s56, v185
    v_dot2c_f32_bf16 v51, v185, v185
    v_dot2_f32_bf16 v60, v139, v45, v47
    v_dot2c_f32_bf16 v50, s56, v186
    v_dot2_f32_bf16 v61, v139, v46, v47
    v_dot2c_f32_bf16 v51, v186, v186
    v_dot2_f32_bf16 v60, v155, v48, v60
    v_dot2c_f32_bf16 v50, s56, v187
    v_dot2_f32_bf16 v61, v155, v49, v61
    v_dot2c_f32_bf16 v51, v187, v187
    buffer_load_dwordx4 v[240:243], v88, s[28:31], s86 offen offset:512
    v_cvt_pk_bf16_f32 v66, v58, v59
    s_waitcnt vmcnt(13)
    v_dot2c_f32_bf16 v50, s56, v188
    v_dot2c_f32_bf16 v51, v188, v188
    v_dot2_f32_bf16 v58, v140, v45, v47
    v_dot2c_f32_bf16 v50, s56, v189
    v_dot2_f32_bf16 v59, v140, v46, v47
    v_dot2c_f32_bf16 v51, v189, v189
    v_dot2_f32_bf16 v58, v156, v48, v58
    v_dot2c_f32_bf16 v50, s56, v190
    v_dot2_f32_bf16 v59, v156, v49, v59
    v_dot2c_f32_bf16 v51, v190, v190
    v_cvt_pk_bf16_f32 v67, v60, v61
    v_dot2c_f32_bf16 v50, s56, v191
    v_dot2c_f32_bf16 v51, v191, v191
    buffer_load_dwordx4 v[244:247], v88, s[28:31], s86 offen offset:640
    ds_write_b128 v5, v[64:67] offset:4096
    v_dot2_f32_bf16 v60, v141, v45, v47
    v_add_f32_dpp v50, v50, v50 quad_perm:[1,0,3,2] row_mask:0xf bank_mask:0xf
    v_dot2_f32_bf16 v61, v141, v46, v47
    v_add_f32_dpp v51, v51, v51 quad_perm:[1,0,3,2] row_mask:0xf bank_mask:0xf
    v_dot2_f32_bf16 v60, v157, v48, v60
    v_add_f32_dpp v50, v50, v50 quad_perm:[2,3,0,1] row_mask:0xf bank_mask:0xf
    v_dot2_f32_bf16 v61, v157, v49, v61
    v_add_f32_dpp v51, v51, v51 quad_perm:[2,3,0,1] row_mask:0xf bank_mask:0xf
    v_cvt_pk_bf16_f32 v68, v58, v59
    v_add_f32_dpp v50, v50, v50 row_half_mirror row_mask:0xf bank_mask:0xf
    v_dot2_f32_bf16 v58, v142, v45, v47
    v_add_f32_dpp v51, v51, v51 row_half_mirror row_mask:0xf bank_mask:0xf
    v_dot2_f32_bf16 v59, v142, v46, v47
    v_mul_f32 v50, 0x3b000000, v50
    v_dot2_f32_bf16 v58, v158, v48, v58
    v_mul_f32 v51, 0x3b000000, v51
    v_fma_f32 v51, -v50, v50, v51
    buffer_load_dwordx4 v[248:251], v88, s[28:31], s86 offen offset:768
    v_dot2_f32_bf16 v59, v158, v49, v59
    v_max_f32 v51, 0, v51
    v_cvt_pk_bf16_f32 v69, v60, v61
    v_add_f32 v51, 0x3727c5ac, v51
    v_dot2_f32_bf16 v60, v143, v45, v47
    v_rsq_f32 v52, v51
    v_dot2_f32_bf16 v61, v143, v46, v47
    v_mul_f32 v55, s97, v50
    v_dot2_f32_bf16 v60, v159, v48, v60
    v_cvt_pk_bf16_f32 v53, v52, 0
    v_dot2_f32_bf16 v61, v159, v49, v61
    v_lshlrev_b32 v54, 16, v53
    v_cvt_pk_bf16_f32 v70, v58, v59
    v_xor_b32 v56, s96, v53
    v_cvt_pk_bf16_f32 v71, v60, v61
    v_mul_f32 v55, v55, v54
    v_lshlrev_b32 v57, 16, v56
    buffer_load_dwordx4 v[252:255], v88, s[28:31], s86 offen offset:896
    ds_write_b128 v5, v[68:71] offset:6144
    s_mov_b32 s57, 0
    s_load_dword s57, s[24:25], 0
    s_mov_b32 vcc_lo, 0xaaaaaaaa
    s_mov_b32 vcc_hi, 0xaaaaaaaa
    v_cndmask_b32 v76, v42, v50, vcc
    v_cndmask_b32 v77, v43, v51, vcc
    v_cndmask_b32 v78, v44, v52, vcc
    v_mul_f32 v73, 0xbe800000, v76
    v_mul_f32 v74, 0xbfb8aa3b, v78
    v_cvt_pk_bf16_f32 v72, v73, v73
    v_mul_f32 v75, v77, v78
    v_lshlrev_b32 v76, 16, v72
    v_sub_f32 v73, v73, v76
    v_cvt_pk_bf16_f32 v73, v73, 0
    buffer_store_dwordx4 v[72:75], v18, s[40:43], s60 offen sc1
    v_dot2_f32_bf16 v58, v160, v53, v55
    v_dot2_f32_bf16 v59, v160, v54, v55
    v_mov_b32 v42, 0
    v_dot2_f32_bf16 v58, v176, v56, v58
    v_mov_b32 v43, 0
    v_dot2_f32_bf16 v59, v176, v57, v59
    s_waitcnt vmcnt(16)
    v_dot2c_f32_bf16 v42, s56, v192
    v_dot2_f32_bf16 v60, v161, v53, v55
    v_dot2_f32_bf16 v61, v161, v54, v55
    v_dot2c_f32_bf16 v43, v192, v192
    v_dot2_f32_bf16 v60, v177, v56, v60
    v_dot2c_f32_bf16 v42, s56, v193
    v_dot2_f32_bf16 v61, v177, v57, v61
    v_dot2c_f32_bf16 v43, v193, v193
    v_cvt_pk_bf16_f32 v64, v58, v59
    v_dot2_f32_bf16 v58, v162, v53, v55
    v_dot2c_f32_bf16 v42, s56, v194
    v_dot2_f32_bf16 v59, v162, v54, v55
    v_dot2c_f32_bf16 v43, v194, v194
    v_dot2_f32_bf16 v58, v178, v56, v58
    v_dot2c_f32_bf16 v42, s56, v195
    s_add_u32 m0, s59, 98304
    s_add_u32 s98, s87, 0
    buffer_load_dwordx4 v1, s[32:35], s98 offen offset:0 lds
    v_dot2_f32_bf16 v59, v178, v57, v59
    v_cvt_pk_bf16_f32 v65, v60, v61
    v_dot2c_f32_bf16 v43, v195, v195
    v_dot2_f32_bf16 v60, v163, v53, v55
    s_waitcnt vmcnt(16)
    v_dot2c_f32_bf16 v42, s56, v196
    v_dot2_f32_bf16 v61, v163, v54, v55
    v_dot2c_f32_bf16 v43, v196, v196
    v_dot2_f32_bf16 v60, v179, v56, v60
    v_dot2_f32_bf16 v61, v179, v57, v61
    v_dot2c_f32_bf16 v42, s56, v197
    v_cvt_pk_bf16_f32 v66, v58, v59
    v_dot2c_f32_bf16 v43, v197, v197
    v_dot2_f32_bf16 v58, v164, v53, v55
    v_dot2c_f32_bf16 v42, s56, v198
    v_dot2_f32_bf16 v59, v164, v54, v55
    v_dot2_f32_bf16 v58, v180, v56, v58
    v_dot2c_f32_bf16 v43, v198, v198
    v_dot2_f32_bf16 v59, v180, v57, v59
    v_dot2c_f32_bf16 v42, s56, v199
    v_cvt_pk_bf16_f32 v67, v60, v61
    v_dot2c_f32_bf16 v43, v199, v199
    buffer_load_dwordx4 v2, s[32:35], s98 offen offset:1024 lds
    ds_write_b128 v5, v[64:67] offset:128
    v_dot2_f32_bf16 v60, v165, v53, v55
    s_waitcnt vmcnt(16)
    v_dot2c_f32_bf16 v42, s56, v200
    v_dot2_f32_bf16 v61, v165, v54, v55
    v_dot2c_f32_bf16 v43, v200, v200
    v_dot2_f32_bf16 v60, v181, v56, v60
    v_dot2c_f32_bf16 v42, s56, v201
    v_dot2_f32_bf16 v61, v181, v57, v61
    v_dot2c_f32_bf16 v43, v201, v201
    v_cvt_pk_bf16_f32 v68, v58, v59
    v_dot2c_f32_bf16 v42, s56, v202
    v_dot2c_f32_bf16 v43, v202, v202
    v_dot2_f32_bf16 v58, v166, v53, v55
    v_dot2c_f32_bf16 v42, s56, v203
    v_dot2_f32_bf16 v59, v166, v54, v55
    v_dot2c_f32_bf16 v43, v203, v203
    buffer_load_dwordx4 v3, s[32:35], s98 offen offset:2048 lds
    v_dot2_f32_bf16 v58, v182, v56, v58
    s_waitcnt vmcnt(16)
    v_dot2c_f32_bf16 v42, s56, v204
    v_dot2_f32_bf16 v59, v182, v57, v59
    v_dot2c_f32_bf16 v43, v204, v204
    v_cvt_pk_bf16_f32 v69, v60, v61
    v_dot2c_f32_bf16 v42, s56, v205
    v_dot2c_f32_bf16 v43, v205, v205
    v_dot2_f32_bf16 v60, v167, v53, v55
    v_dot2c_f32_bf16 v42, s56, v206
    v_dot2_f32_bf16 v61, v167, v54, v55
    v_dot2c_f32_bf16 v43, v206, v206
    v_dot2_f32_bf16 v60, v183, v56, v60
    v_dot2c_f32_bf16 v42, s56, v207
    v_dot2_f32_bf16 v61, v183, v57, v61
    v_dot2c_f32_bf16 v43, v207, v207
    buffer_load_dwordx4 v4, s[32:35], s98 offen offset:3072 lds
    v_cvt_pk_bf16_f32 v70, v58, v59
    s_waitcnt vmcnt(16)
    v_dot2c_f32_bf16 v42, s56, v208
    v_dot2c_f32_bf16 v43, v208, v208
    v_dot2_f32_bf16 v58, v168, v53, v55
    v_dot2c_f32_bf16 v42, s56, v209
    v_dot2_f32_bf16 v59, v168, v54, v55
    v_dot2c_f32_bf16 v43, v209, v209
    v_dot2_f32_bf16 v58, v184, v56, v58
    v_dot2c_f32_bf16 v42, s56, v210
    v_dot2_f32_bf16 v59, v184, v57, v59
    v_dot2c_f32_bf16 v43, v210, v210
    v_cvt_pk_bf16_f32 v71, v60, v61
    v_dot2c_f32_bf16 v42, s56, v211
    v_dot2c_f32_bf16 v43, v211, v211
    s_add_u32 m0, s59, 114688
    s_add_u32 s98, s87, 0
    buffer_load_dwordx4 v1, s[36:39], s98 offen offset:0 lds
    ds_write_b128 v5, v[68:71] offset:2176
    v_dot2_f32_bf16 v60, v169, v53, v55
    s_waitcnt vmcnt(16)
    v_dot2c_f32_bf16 v42, s56, v212
    v_dot2_f32_bf16 v61, v169, v54, v55
    v_dot2c_f32_bf16 v43, v212, v212
    v_dot2_f32_bf16 v60, v185, v56, v60
    v_dot2c_f32_bf16 v42, s56, v213
    v_dot2_f32_bf16 v61, v185, v57, v61
    v_dot2c_f32_bf16 v43, v213, v213
    v_cvt_pk_bf16_f32 v64, v58, v59
    v_dot2c_f32_bf16 v42, s56, v214
    v_dot2c_f32_bf16 v43, v214, v214
    v_dot2_f32_bf16 v58, v170, v53, v55
    v_dot2c_f32_bf16 v42, s56, v215
    v_dot2_f32_bf16 v59, v170, v54, v55
    v_dot2c_f32_bf16 v43, v215, v215
    buffer_load_dwordx4 v2, s[36:39], s98 offen offset:1024 lds
    v_dot2_f32_bf16 v58, v186, v56, v58
    s_waitcnt vmcnt(16)
    v_dot2c_f32_bf16 v42, s56, v216
    v_dot2_f32_bf16 v59, v186, v57, v59
    v_dot2c_f32_bf16 v43, v216, v216
    v_cvt_pk_bf16_f32 v65, v60, v61
    v_dot2c_f32_bf16 v42, s56, v217
    v_dot2c_f32_bf16 v43, v217, v217
    v_dot2_f32_bf16 v60, v171, v53, v55
    v_dot2c_f32_bf16 v42, s56, v218
    v_dot2_f32_bf16 v61, v171, v54, v55
    v_dot2c_f32_bf16 v43, v218, v218
    v_dot2_f32_bf16 v60, v187, v56, v60
    v_dot2c_f32_bf16 v42, s56, v219
    v_dot2_f32_bf16 v61, v187, v57, v61
    v_dot2c_f32_bf16 v43, v219, v219
    buffer_load_dwordx4 v3, s[36:39], s98 offen offset:2048 lds
    v_cvt_pk_bf16_f32 v66, v58, v59
    s_waitcnt vmcnt(16)
    v_dot2c_f32_bf16 v42, s56, v220
    v_dot2c_f32_bf16 v43, v220, v220
    v_dot2_f32_bf16 v58, v172, v53, v55
    v_dot2c_f32_bf16 v42, s56, v221
    v_dot2_f32_bf16 v59, v172, v54, v55
    v_dot2c_f32_bf16 v43, v221, v221
    v_dot2_f32_bf16 v58, v188, v56, v58
    v_dot2c_f32_bf16 v42, s56, v222
    v_dot2_f32_bf16 v59, v188, v57, v59
    v_dot2c_f32_bf16 v43, v222, v222
    v_cvt_pk_bf16_f32 v67, v60, v61
    v_dot2c_f32_bf16 v42, s56, v223
    v_dot2c_f32_bf16 v43, v223, v223
    buffer_load_dwordx4 v4, s[36:39], s98 offen offset:3072 lds
    ds_write_b128 v5, v[64:67] offset:4224
    s_cmp_ge_u32 s57, 32
    s_cbranch_scc0 SL_clrd
BK_clrd:
    s_waitcnt vmcnt(8)
    s_atomic_add s58, s[26:27], s52
    v_dot2_f32_bf16 v60, v173, v53, v55
    v_add_f32_dpp v42, v42, v42 quad_perm:[1,0,3,2] row_mask:0xf bank_mask:0xf
    v_dot2_f32_bf16 v61, v173, v54, v55
    v_add_f32_dpp v43, v43, v43 quad_perm:[1,0,3,2] row_mask:0xf bank_mask:0xf
    v_dot2_f32_bf16 v60, v189, v56, v60
    v_add_f32_dpp v42, v42, v42 quad_perm:[2,3,0,1] row_mask:0xf bank_mask:0xf
    v_dot2_f32_bf16 v61, v189, v57, v61
    v_add_f32_dpp v43, v43, v43 quad_perm:[2,3,0,1] row_mask:0xf bank_mask:0xf
    v_cvt_pk_bf16_f32 v68, v58, v59
    v_add_f32_dpp v42, v42, v42 row_half_mirror row_mask:0xf bank_mask:0xf
    v_dot2_f32_bf16 v58, v174, v53, v55
    v_add_f32_dpp v43, v43, v43 row_half_mirror row_mask:0xf bank_mask:0xf
    v_dot2_f32_bf16 v59, v174, v54, v55
    v_mul_f32 v42, 0x3b000000, v42
    v_dot2_f32_bf16 v58, v190, v56, v58
    v_mul_f32 v43, 0x3b000000, v43
    v_fma_f32 v43, -v42, v42, v43
    s_add_u32 m0, s59, 131072
    s_add_u32 s98, s87, 128
    buffer_load_dwordx4 v1, s[32:35], s98 offen offset:0 lds
    v_dot2_f32_bf16 v59, v190, v57, v59
    v_max_f32 v43, 0, v43
    v_cvt_pk_bf16_f32 v69, v60, v61
    v_add_f32 v43, 0x3727c5ac, v43
    v_dot2_f32_bf16 v60, v175, v53, v55
    v_rsq_f32 v44, v43
    v_dot2_f32_bf16 v61, v175, v54, v55
    v_mul_f32 v47, s97, v42
    v_dot2_f32_bf16 v60, v191, v56, v60
    v_cvt_pk_bf16_f32 v45, v44, 0
    v_dot2_f32_bf16 v61, v191, v57, v61
    v_lshlrev_b32 v46, 16, v45
    v_cvt_pk_bf16_f32 v70, v58, v59
    v_xor_b32 v48, s96, v45
    v_cvt_pk_bf16_f32 v71, v60, v61
    v_mul_f32 v47, v47, v46
    v_lshlrev_b32 v49, 16, v48
    buffer_load_dwordx4 v2, s[32:35], s98 offen offset:1024 lds
    ds_write_b128 v5, v[68:71] offset:6272
    v_xor_b32 v5, 0x2000, v5
    v_dot2_f32_bf16 v58, v192, v45, v47
    v_dot2_f32_bf16 v59, v192, v46, v47
    v_mov_b32 v50, 0
    v_dot2_f32_bf16 v58, v208, v48, v58
    v_mov_b32 v51, 0
    v_dot2_f32_bf16 v59, v208, v49, v59
    v_dot2c_f32_bf16 v50, s56, v224
    v_dot2_f32_bf16 v60, v193, v45, v47
    v_dot2_f32_bf16 v61, v193, v46, v47
    v_dot2c_f32_bf16 v51, v224, v224
    v_dot2_f32_bf16 v60, v209, v48, v60
    v_dot2c_f32_bf16 v50, s56, v225
    v_dot2_f32_bf16 v61, v209, v49, v61
    v_dot2c_f32_bf16 v51, v225, v225
    v_cvt_pk_bf16_f32 v64, v58, v59
    v_dot2_f32_bf16 v58, v194, v45, v47
    v_dot2c_f32_bf16 v50, s56, v226
    v_dot2_f32_bf16 v59, v194, v46, v47
    v_dot2c_f32_bf16 v51, v226, v226
    v_dot2_f32_bf16 v58, v210, v48, v58
    v_dot2c_f32_bf16 v50, s56, v227
    buffer_load_dwordx4 v3, s[32:35], s98 offen offset:2048 lds
    v_dot2_f32_bf16 v59, v210, v49, v59
    v_cvt_pk_bf16_f32 v65, v60, v61
    v_dot2c_f32_bf16 v51, v227, v227
    v_dot2_f32_bf16 v60, v195, v45, v47
    v_dot2c_f32_bf16 v50, s56, v228
    v_dot2_f32_bf16 v61, v195, v46, v47
    v_dot2c_f32_bf16 v51, v228, v228
    v_dot2_f32_bf16 v60, v211, v48, v60
    v_dot2_f32_bf16 v61, v211, v49, v61
    v_dot2c_f32_bf16 v50, s56, v229
    v_cvt_pk_bf16_f32 v66, v58, v59
    v_dot2c_f32_bf16 v51, v229, v229
    v_dot2_f32_bf16 v58, v196, v45, v47
    v_dot2c_f32_bf16 v50, s56, v230
    v_dot2_f32_bf16 v59, v196, v46, v47
    v_dot2_f32_bf16 v58, v212, v48, v58
    v_dot2c_f32_bf16 v51, v230, v230
    v_dot2_f32_bf16 v59, v212, v49, v59
    v_dot2c_f32_bf16 v50, s56, v231
    v_cvt_pk_bf16_f32 v67, v60, v61
    v_dot2c_f32_bf16 v51, v231, v231
    buffer_load_dwordx4 v4, s[32:35], s98 offen offset:3072 lds
    ds_write_b128 v5, v[64:67] offset:0
    v_dot2_f32_bf16 v60, v197, v45, v47
    v_dot2c_f32_bf16 v50, s56, v232
HD1:
    s_cbranch_execz HBD
    v_dot2_f32_bf16 v61, v197, v46, v47
    v_dot2c_f32_bf16 v51, v232, v232
    v_dot2_f32_bf16 v60, v213, v48, v60
    v_dot2c_f32_bf16 v50, s56, v233
    v_dot2_f32_bf16 v61, v213, v49, v61
    v_dot2c_f32_bf16 v51, v233, v233
    v_cvt_pk_bf16_f32 v68, v58, v59
    v_dot2c_f32_bf16 v50, s56, v234
    v_dot2c_f32_bf16 v51, v234, v234
    v_dot2_f32_bf16 v58, v198, v45, v47
    v_dot2c_f32_bf16 v50, s56, v235
    v_dot2_f32_bf16 v59, v198, v46, v47
    v_dot2c_f32_bf16 v51, v235, v235
    s_add_u32 m0, s59, 147456
    s_add_u32 s98, s87, 128
    buffer_load_dwordx4 v1, s[36:39], s98 offen offset:0 lds
    v_dot2_f32_bf16 v58, v214, v48, v58
    v_dot2c_f32_bf16 v50, s56, v236
    v_dot2_f32_bf16 v59, v214, v49, v59
    v_dot2c_f32_bf16 v51, v236, v236
    v_cvt_pk_bf16_f32 v69, v60, v61
    v_dot2c_f32_bf16 v50, s56, v237
    v_dot2c_f32_bf16 v51, v237, v237
    v_dot2_f32_bf16 v60, v199, v45, v47
    v_dot2c_f32_bf16 v50, s56, v238
    v_dot2_f32_bf16 v61, v199, v46, v47
    v_dot2c_f32_bf16 v51, v238, v238
    v_dot2_f32_bf16 v60, v215, v48, v60
    v_dot2c_f32_bf16 v50, s56, v239
    v_dot2_f32_bf16 v61, v215, v49, v61
    v_dot2c_f32_bf16 v51, v239, v239
    buffer_load_dwordx4 v2, s[36:39], s98 offen offset:1024 lds
    v_cvt_pk_bf16_f32 v70, v58, v59
    v_dot2c_f32_bf16 v50, s56, v240
    v_dot2c_f32_bf16 v51, v240, v240
    v_dot2_f32_bf16 v58, v200, v45, v47
    v_dot2c_f32_bf16 v50, s56, v241
    v_dot2_f32_bf16 v59, v200, v46, v47
    v_dot2c_f32_bf16 v51, v241, v241
    v_dot2_f32_bf16 v58, v216, v48, v58
    v_dot2c_f32_bf16 v50, s56, v242
    v_dot2_f32_bf16 v59, v216, v49, v59
    v_dot2c_f32_bf16 v51, v242, v242
    v_cvt_pk_bf16_f32 v71, v60, v61
    v_dot2c_f32_bf16 v50, s56, v243
    v_dot2c_f32_bf16 v51, v243, v243
    buffer_load_dwordx4 v3, s[36:39], s98 offen offset:2048 lds
    ds_write_b128 v5, v[68:71] offset:2048
    v_dot2_f32_bf16 v60, v201, v45, v47
    v_dot2c_f32_bf16 v50, s56, v244
    v_dot2_f32_bf16 v61, v201, v46, v47
    v_dot2c_f32_bf16 v51, v244, v244
    v_dot2_f32_bf16 v60, v217, v48, v60
    v_dot2c_f32_bf16 v50, s56, v245
    v_dot2_f32_bf16 v61, v217, v49, v61
    v_dot2c_f32_bf16 v51, v245, v245
    v_cvt_pk_bf16_f32 v64, v58, v59
    v_dot2c_f32_bf16 v50, s56, v246
    v_dot2c_f32_bf16 v51, v246, v246
    v_dot2_f32_bf16 v58, v202, v45, v47
    v_dot2c_f32_bf16 v50, s56, v247
    v_dot2_f32_bf16 v59, v202, v46, v47
    v_dot2c_f32_bf16 v51, v247, v247
    buffer_load_dwordx4 v4, s[36:39], s98 offen offset:3072 lds
    v_dot2_f32_bf16 v58, v218, v48, v58
    v_dot2c_f32_bf16 v50, s56, v248
    v_dot2_f32_bf16 v59, v218, v49, v59
    v_dot2c_f32_bf16 v51, v248, v248
    v_cvt_pk_bf16_f32 v65, v60, v61
    v_dot2c_f32_bf16 v50, s56, v249
    v_dot2c_f32_bf16 v51, v249, v249
    v_dot2_f32_bf16 v60, v203, v45, v47
    v_dot2c_f32_bf16 v50, s56, v250
    v_dot2_f32_bf16 v61, v203, v46, v47
    v_dot2c_f32_bf16 v51, v250, v250
    v_dot2_f32_bf16 v60, v219, v48, v60
    v_dot2c_f32_bf16 v50, s56, v251
    v_dot2_f32_bf16 v61, v219, v49, v61
    v_dot2c_f32_bf16 v51, v251, v251
    s_add_u32 m0, s59, 0
    s_add_u32 s67, s64, 786432
    buffer_load_dwordx4 v24, s[44:47], s67 offen offset:0 lds
    v_cvt_pk_bf16_f32 v66, v58, v59
    v_dot2c_f32_bf16 v50, s56, v252
    v_dot2c_f32_bf16 v51, v252, v252
    v_dot2_f32_bf16 v58, v204, v45, v47
    v_dot2c_f32_bf16 v50, s56, v253
    v_dot2_f32_bf16 v59, v204, v46, v47
    v_dot2c_f32_bf16 v51, v253, v253
    v_dot2_f32_bf16 v58, v220, v48, v58
    v_dot2c_f32_bf16 v50, s56, v254
    v_dot2_f32_bf16 v59, v220, v49, v59
    v_dot2c_f32_bf16 v51, v254, v254
    v_cvt_pk_bf16_f32 v67, v60, v61
    v_dot2c_f32_bf16 v50, s56, v255
    v_dot2c_f32_bf16 v51, v255, v255
    buffer_load_dwordx4 v25, s[44:47], s67 offen offset:1024 lds
    ds_write_b128 v5, v[64:67] offset:4096
    v_dot2_f32_bf16 v60, v205, v45, v47
    v_add_f32_dpp v50, v50, v50 quad_perm:[1,0,3,2] row_mask:0xf bank_mask:0xf
    v_dot2_f32_bf16 v61, v205, v46, v47
    v_add_f32_dpp v51, v51, v51 quad_perm:[1,0,3,2] row_mask:0xf bank_mask:0xf
    v_dot2_f32_bf16 v60, v221, v48, v60
    v_add_f32_dpp v50, v50, v50 quad_perm:[2,3,0,1] row_mask:0xf bank_mask:0xf
    v_dot2_f32_bf16 v61, v221, v49, v61
    v_add_f32_dpp v51, v51, v51 quad_perm:[2,3,0,1] row_mask:0xf bank_mask:0xf
    v_cvt_pk_bf16_f32 v68, v58, v59
    v_add_f32_dpp v50, v50, v50 row_half_mirror row_mask:0xf bank_mask:0xf
    v_dot2_f32_bf16 v58, v206, v45, v47
    v_add_f32_dpp v51, v51, v51 row_half_mirror row_mask:0xf bank_mask:0xf
    v_dot2_f32_bf16 v59, v206, v46, v47
    v_mul_f32 v50, 0x3b000000, v50
    v_dot2_f32_bf16 v58, v222, v48, v58
    v_mul_f32 v51, 0x3b000000, v51
    v_fma_f32 v51, -v50, v50, v51
    buffer_load_dwordx4 v26, s[44:47], s67 offen offset:2048 lds
    v_dot2_f32_bf16 v59, v222, v49, v59
    v_max_f32 v51, 0, v51
    v_cvt_pk_bf16_f32 v69, v60, v61
    v_add_f32 v51, 0x3727c5ac, v51
    v_dot2_f32_bf16 v60, v207, v45, v47
    v_rsq_f32 v52, v51
    v_dot2_f32_bf16 v61, v207, v46, v47
    v_mul_f32 v55, s97, v50
    v_dot2_f32_bf16 v60, v223, v48, v60
    v_cvt_pk_bf16_f32 v53, v52, 0
    v_dot2_f32_bf16 v61, v223, v49, v61
    v_lshlrev_b32 v54, 16, v53
    v_cvt_pk_bf16_f32 v70, v58, v59
    v_xor_b32 v56, s96, v53
    v_cvt_pk_bf16_f32 v71, v60, v61
    v_mul_f32 v55, v55, v54
    v_lshlrev_b32 v57, 16, v56
    buffer_load_dwordx4 v27, s[44:47], s67 offen offset:3072 lds
    ds_write_b128 v5, v[68:71] offset:6144
    v_dot2_f32_bf16 v58, v224, v53, v55
    v_dot2_f32_bf16 v59, v224, v54, v55
    v_dot2_f32_bf16 v58, v240, v56, v58
    v_dot2_f32_bf16 v59, v240, v57, v59
    v_dot2_f32_bf16 v60, v225, v53, v55
    v_dot2_f32_bf16 v61, v225, v54, v55
    v_dot2_f32_bf16 v60, v241, v56, v60
    v_dot2_f32_bf16 v61, v241, v57, v61
    v_cvt_pk_bf16_f32 v64, v58, v59
    v_dot2_f32_bf16 v58, v226, v53, v55
    v_dot2_f32_bf16 v59, v226, v54, v55
    v_dot2_f32_bf16 v58, v242, v56, v58
    v_dot2_f32_bf16 v59, v242, v57, v59
    v_cvt_pk_bf16_f32 v65, v60, v61
    v_dot2_f32_bf16 v60, v227, v53, v55
    v_dot2_f32_bf16 v61, v227, v54, v55
    v_dot2_f32_bf16 v60, v243, v56, v60
    v_dot2_f32_bf16 v61, v243, v57, v61
    v_cvt_pk_bf16_f32 v66, v58, v59
    v_dot2_f32_bf16 v58, v228, v53, v55
    v_dot2_f32_bf16 v59, v228, v54, v55
    v_dot2_f32_bf16 v58, v244, v56, v58
    v_dot2_f32_bf16 v59, v244, v57, v59
    v_cvt_pk_bf16_f32 v67, v60, v61
    ds_write_b128 v5, v[64:67] offset:128
    v_dot2_f32_bf16 v60, v229, v53, v55
    v_dot2_f32_bf16 v61, v229, v54, v55
    v_dot2_f32_bf16 v60, v245, v56, v60
    v_dot2_f32_bf16 v61, v245, v57, v61
    v_cvt_pk_bf16_f32 v68, v58, v59
    v_dot2_f32_bf16 v58, v230, v53, v55
    v_dot2_f32_bf16 v59, v230, v54, v55
    v_dot2_f32_bf16 v58, v246, v56, v58
    v_dot2_f32_bf16 v59, v246, v57, v59
    v_cvt_pk_bf16_f32 v69, v60, v61
    v_dot2_f32_bf16 v60, v231, v53, v55
    v_dot2_f32_bf16 v61, v231, v54, v55
    v_dot2_f32_bf16 v60, v247, v56, v60
    v_dot2_f32_bf16 v61, v247, v57, v61
    v_cvt_pk_bf16_f32 v70, v58, v59
    v_dot2_f32_bf16 v58, v232, v53, v55
    v_dot2_f32_bf16 v59, v232, v54, v55
    v_dot2_f32_bf16 v58, v248, v56, v58
    v_dot2_f32_bf16 v59, v248, v57, v59
    v_cvt_pk_bf16_f32 v71, v60, v61
    ds_write_b128 v5, v[68:71] offset:2176
    v_dot2_f32_bf16 v60, v233, v53, v55
    v_dot2_f32_bf16 v61, v233, v54, v55
    v_dot2_f32_bf16 v60, v249, v56, v60
    v_dot2_f32_bf16 v61, v249, v57, v61
    v_cvt_pk_bf16_f32 v64, v58, v59
    v_dot2_f32_bf16 v58, v234, v53, v55
    v_dot2_f32_bf16 v59, v234, v54, v55
    v_dot2_f32_bf16 v58, v250, v56, v58
    v_dot2_f32_bf16 v59, v250, v57, v59
    v_cvt_pk_bf16_f32 v65, v60, v61
    v_dot2_f32_bf16 v60, v235, v53, v55
    v_dot2_f32_bf16 v61, v235, v54, v55
    v_dot2_f32_bf16 v60, v251, v56, v60
    v_dot2_f32_bf16 v61, v251, v57, v61
    v_cvt_pk_bf16_f32 v66, v58, v59
    v_dot2_f32_bf16 v58, v236, v53, v55
    v_dot2_f32_bf16 v59, v236, v54, v55
    v_dot2_f32_bf16 v58, v252, v56, v58
    v_dot2_f32_bf16 v59, v252, v57, v59
    v_cvt_pk_bf16_f32 v67, v60, v61
    ds_write_b128 v5, v[64:67] offset:4224
    v_dot2_f32_bf16 v60, v237, v53, v55
    v_dot2_f32_bf16 v61, v237, v54, v55
    v_dot2_f32_bf16 v60, v253, v56, v60
    v_dot2_f32_bf16 v61, v253, v57, v61
    v_cvt_pk_bf16_f32 v68, v58, v59
    v_dot2_f32_bf16 v58, v238, v53, v55
    v_dot2_f32_bf16 v59, v238, v54, v55
    v_dot2_f32_bf16 v58, v254, v56, v58
    v_dot2_f32_bf16 v59, v254, v57, v59
    v_cvt_pk_bf16_f32 v69, v60, v61
    v_dot2_f32_bf16 v60, v239, v53, v55
    v_dot2_f32_bf16 v61, v239, v54, v55
    v_dot2_f32_bf16 v60, v255, v56, v60
    v_dot2_f32_bf16 v61, v255, v57, v61
    v_cvt_pk_bf16_f32 v70, v58, v59
    s_nop 1
    v_cvt_pk_bf16_f32 v71, v60, v61
    ds_write_b128 v5, v[68:71] offset:6272
    v_and_b32 v86, 15, v0
    v_lshrrev_b32 v87, 1, v86
    v_lshrrev_b32 v40, 4, v0
    v_xor_b32 v87, v87, v40
    v_lshlrev_b32 v87, 4, v87
    v_lshl_add_u32 v87, v86, 7, v87
    s_add_u32 s54, s59, 98304
    v_add_u32 v11, s54, v87
    v_xor_b32 v12, 64, v11
    v_xor_b32 v87, v86, v40
    v_lshlrev_b32 v87, 4, v87
    v_lshl_add_u32 v87, v40, 8, v87
    v_add_u32 v15, 16384, v87
    v_xor_b32 v16, 64, v15
    s_waitcnt vmcnt(12) lgkmcnt(0)
    s_barrier
    ds_read_b128 a[0:3], v11 offset:0
    ds_read_b128 a[4:7], v11 offset:2048
    ds_read_b128 a[8:11], v11 offset:16384
    ds_read_b128 a[12:15], v11 offset:18432
    ds_read_b128 v[64:67], v15 offset:0
    ds_read_b128 v[68:71], v15 offset:8192
    ds_read_b128 v[72:75], v15 offset:16384
    ds_read_b128 v[76:79], v15 offset:24576
    s_waitcnt lgkmcnt(3)
    v_mfma_f32_16x16x32_bf16 v[128:131], v[64:67], a[0:3], 0
    ds_read_b128 v[80:83], v15 offset:32768
    s_add_u32 m0, s59, 81920
    s_add_u32 s67, s64, 655360
    v_mfma_f32_16x16x32_bf16 v[132:135], v[64:67], a[4:7], 0
    buffer_load_dwordx4 v24, s[44:47], s67 offen offset:0 lds
    s_lshl_b32 s54, s85, 14
    s_xor_b32 s55, s54, 0x4000
    v_mfma_f32_16x16x32_bf16 v[136:139], v[64:67], a[8:11], 0
    v_add_u32 v13, s55, v11
    v_add_u32 v14, s55, v12
    v_mfma_f32_16x16x32_bf16 v[140:143], v[64:67], a[12:15], 0
    s_waitcnt lgkmcnt(3)
    v_add_u32 v54, s54, v11
    v_add_u32 v55, s54, v12
    v_mfma_f32_16x16x32_bf16 v[144:147], v[68:71], a[0:3], 0
    ds_read_b128 v[84:87], v15 offset:40960
    buffer_load_dwordx4 v25, s[44:47], s67 offen offset:1024 lds
    v_mfma_f32_16x16x32_bf16 v[148:151], v[68:71], a[4:7], 0
    v_and_b32 v59, 1, v0
    v_add_u32 v59, -1, v59
    v_mfma_f32_16x16x32_bf16 v[152:155], v[68:71], a[8:11], 0
    v_and_b32 v59, 0x80008000, v59
    s_mul_i32 s54, s96, 0x10001
    v_mfma_f32_16x16x32_bf16 v[156:159], v[68:71], a[12:15], 0
    s_waitcnt lgkmcnt(3)
    v_xor_b32 v58, s54, v59
    v_and_b32 v56, 15, v0
    v_mfma_f32_16x16x32_bf16 v[160:163], v[72:75], a[0:3], 0
    ds_read_b128 v[88:91], v15 offset:49152
    ds_read_b128 a[16:19], v12 offset:0
    v_mfma_f32_16x16x32_bf16 v[164:167], v[72:75], a[4:7], 0
    buffer_load_dwordx4 v26, s[44:47], s67 offen offset:2048 lds
    ds_read_b128 a[20:23], v12 offset:2048
    v_mfma_f32_16x16x32_bf16 v[168:171], v[72:75], a[8:11], 0
    ds_read_b128 a[24:27], v12 offset:16384
    ds_read_b128 a[28:31], v12 offset:18432
    v_mfma_f32_16x16x32_bf16 v[172:175], v[72:75], a[12:15], 0
    s_waitcnt lgkmcnt(7)
    ds_read_b128 v[96:99], v13 offset:0
    v_mfma_f32_16x16x32_bf16 v[176:179], v[76:79], a[0:3], 0
    ds_read_b128 v[92:95], v15 offset:57344
    ds_read_b128 v[100:103], v13 offset:2048
    v_mfma_f32_16x16x32_bf16 v[180:183], v[76:79], a[4:7], 0
    ds_read_b128 v[104:107], v54 offset:0
    ds_read_b128 v[108:111], v54 offset:2048
    v_mfma_f32_16x16x32_bf16 v[184:187], v[76:79], a[8:11], 0
    buffer_load_dwordx4 v27, s[44:47], s67 offen offset:3072 lds
    ds_read_b128 v[112:115], v14 offset:0
    v_mfma_f32_16x16x32_bf16 v[188:191], v[76:79], a[12:15], 0
    s_waitcnt lgkmcnt(12)
    ds_read_b128 v[116:119], v14 offset:2048
    v_mfma_f32_16x16x32_bf16 v[192:195], v[80:83], a[0:3], 0
    ds_read_b128 v[64:67], v16 offset:1024
    ds_read_b128 v[120:123], v55 offset:0
    v_mfma_f32_16x16x32_bf16 v[196:199], v[80:83], a[4:7], 0
    ds_read_b128 v[124:127], v55 offset:2048
    s_waitcnt lgkmcnt(0)
    s_add_u32 m0, s59, 98304
    v_mfma_f32_16x16x32_bf16 v[200:203], v[80:83], a[8:11], 0
    s_add_u32 s67, s62, 917504
    buffer_load_dwordx4 v24, s[44:47], s67 offen offset:0 lds
    s_waitcnt vmcnt(9)
    v_mfma_f32_16x16x32_bf16 v[204:207], v[80:83], a[12:15], 0
    ds_read_b128 a[32:35], v11 offset:32768
    v_mfma_f32_16x16x32_bf16 v[208:211], v[84:87], a[0:3], 0
    ds_read_b128 v[68:71], v16 offset:9216
    ds_read_b128 a[36:39], v11 offset:34816
    v_mfma_f32_16x16x32_bf16 v[212:215], v[84:87], a[4:7], 0
    ds_read_b128 a[40:43], v11 offset:49152
    ds_read_b128 a[44:47], v11 offset:51200
    v_mfma_f32_16x16x32_bf16 v[216:219], v[84:87], a[8:11], 0
    ds_read_b128 a[48:51], v12 offset:32768
    ds_read_b128 a[52:55], v12 offset:34816
    v_mfma_f32_16x16x32_bf16 v[220:223], v[84:87], a[12:15], 0
    buffer_load_dwordx4 v25, s[44:47], s67 offen offset:1024 lds
    v_mfma_f32_16x16x32_bf16 v[224:227], v[88:91], a[0:3], 0
    ds_read_b128 v[72:75], v16 offset:17408
    ds_read_b128 a[56:59], v12 offset:49152
    v_mfma_f32_16x16x32_bf16 v[228:231], v[88:91], a[4:7], 0
    ds_read_b128 a[60:63], v12 offset:51200
    ds_read_b128 a[64:67], v13 offset:32768
    v_mfma_f32_16x16x32_bf16 v[232:235], v[88:91], a[8:11], 0
    ds_read_b128 a[68:71], v13 offset:34816
    ds_read_b128 a[72:75], v54 offset:32768
    v_mfma_f32_16x16x32_bf16 v[236:239], v[88:91], a[12:15], 0
    ds_read_b128 a[76:79], v54 offset:34816
    v_mfma_f32_16x16x32_bf16 v[240:243], v[92:95], a[0:3], 0
    ds_read_b128 v[76:79], v16 offset:25600
    buffer_load_dwordx4 v26, s[44:47], s67 offen offset:2048 lds
    v_mfma_f32_16x16x32_bf16 v[244:247], v[92:95], a[4:7], 0
    ds_read_b128 a[80:83], v14 offset:32768
    ds_read_b128 a[84:87], v14 offset:34816
    v_mfma_f32_16x16x32_bf16 v[248:251], v[92:95], a[8:11], 0
    ds_read_b128 a[88:91], v55 offset:32768
    ds_read_b128 a[92:95], v55 offset:34816
    v_mfma_f32_16x16x32_bf16 v[252:255], v[92:95], a[12:15], 0
    v_xor_b32 v96, v58, v96
    v_xor_b32 v97, v58, v97
    v_mfma_f32_16x16x32_bf16 v[128:131], v[64:67], a[16:19], v[128:131]
    ds_read_b128 v[80:83], v16 offset:33792
    v_xor_b32 v98, v58, v98
    v_mfma_f32_16x16x32_bf16 v[132:135], v[64:67], a[20:23], v[132:135]
    buffer_load_dwordx4 v27, s[44:47], s67 offen offset:3072 lds
    s_add_u32 m0, s59, 114688
    s_add_u32 s67, s62, 1048576
    v_mfma_f32_16x16x32_bf16 v[136:139], v[64:67], a[24:27], v[136:139]
    v_xor_b32 v99, v58, v99
    v_xor_b32 v100, v58, v100
    v_mfma_f32_16x16x32_bf16 v[140:143], v[64:67], a[28:31], v[140:143]
    s_waitcnt lgkmcnt(15)
    v_xor_b32 v101, v58, v101
    v_xor_b32 v102, v58, v102
    v_mfma_f32_16x16x32_bf16 v[144:147], v[68:71], a[16:19], v[144:147]
    ds_read_b128 v[84:87], v16 offset:41984
    v_xor_b32 v103, v58, v103
    v_mfma_f32_16x16x32_bf16 v[148:151], v[68:71], a[20:23], v[148:151]
    v_xor_b32 v104, v59, v104
    v_xor_b32 v105, v59, v105
    v_mfma_f32_16x16x32_bf16 v[152:155], v[68:71], a[24:27], v[152:155]
    buffer_load_dwordx4 v24, s[44:47], s67 offen offset:0 lds
    v_xor_b32 v106, v59, v106
    v_mfma_f32_16x16x32_bf16 v[156:159], v[68:71], a[28:31], v[156:159]
    s_waitcnt lgkmcnt(13)
    v_xor_b32 v107, v59, v107
    v_xor_b32 v108, v59, v108
    v_mfma_f32_16x16x32_bf16 v[160:163], v[72:75], a[16:19], v[160:163]
    ds_read_b128 v[88:91], v16 offset:50176
    v_xor_b32 v109, v59, v109
    v_mfma_f32_16x16x32_bf16 v[164:167], v[72:75], a[20:23], v[164:167]
    v_xor_b32 v110, v59, v110
    v_xor_b32 v111, v59, v111
    v_mfma_f32_16x16x32_bf16 v[168:171], v[72:75], a[24:27], v[168:171]
    v_xor_b32 v112, v58, v112
    v_xor_b32 v113, v58, v113
    v_mfma_f32_16x16x32_bf16 v[172:175], v[72:75], a[28:31], v[172:175]
    s_waitcnt lgkmcnt(7)
    buffer_load_dwordx4 v25, s[44:47], s67 offen offset:1024 lds
    v_mfma_f32_16x16x32_bf16 v[176:179], v[76:79], a[16:19], v[176:179]
    ds_read_b128 v[92:95], v16 offset:58368
    v_xor_b32 v114, v58, v114
    v_mfma_f32_16x16x32_bf16 v[180:183], v[76:79], a[20:23], v[180:183]
    v_xor_b32 v115, v58, v115
    v_xor_b32 v116, v58, v116
    v_mfma_f32_16x16x32_bf16 v[184:187], v[76:79], a[24:27], v[184:187]
    v_xor_b32 v117, v58, v117
    v_xor_b32 v118, v58, v118
    v_mfma_f32_16x16x32_bf16 v[188:191], v[76:79], a[28:31], v[188:191]
    s_waitcnt lgkmcnt(3)
    v_xor_b32 v119, v58, v119
    v_xor_b32 v120, v59, v120
    v_mfma_f32_16x16x32_bf16 v[192:195], v[80:83], a[16:19], v[192:195]
    ds_read_b128 v[64:67], v15 offset:2048
    buffer_load_dwordx4 v26, s[44:47], s67 offen offset:2048 lds
    v_mfma_f32_16x16x32_bf16 v[196:199], v[80:83], a[20:23], v[196:199]
    v_xor_b32 v121, v59, v121
    v_xor_b32 v122, v59, v122
    v_mfma_f32_16x16x32_bf16 v[200:203], v[80:83], a[24:27], v[200:203]
    v_xor_b32 v123, v59, v123
    v_xor_b32 v124, v59, v124
    v_mfma_f32_16x16x32_bf16 v[204:207], v[80:83], a[28:31], v[204:207]
    s_waitcnt lgkmcnt(3)
    v_xor_b32 v125, v59, v125
    v_xor_b32 v126, v59, v126
    v_mfma_f32_16x16x32_bf16 v[208:211], v[84:87], a[16:19], v[208:211]
    ds_read_b128 v[68:71], v15 offset:10240
    v_xor_b32 v127, v59, v127
    v_mfma_f32_16x16x32_bf16 v[212:215], v[84:87], a[20:23], v[212:215]
    buffer_load_dwordx4 v27, s[44:47], s67 offen offset:3072 lds
    s_add_u32 m0, s59, 131072
    v_mfma_f32_16x16x32_bf16 v[216:219], v[84:87], a[24:27], v[216:219]
    s_add_u32 s67, s62, 1179648
    v_lshlrev_b32 v57, 4, v56
    v_lshl_add_u32 v6, v40, 18, v57
    v_mfma_f32_16x16x32_bf16 v[220:223], v[84:87], a[28:31], v[220:223]
    s_waitcnt lgkmcnt(3)
    s_lshl_b32 s54, s84, 12
    s_lshl_b32 s55, s85, 11
    v_mfma_f32_16x16x32_bf16 v[224:227], v[88:91], a[16:19], v[224:227]
    ds_read_b128 v[72:75], v15 offset:18432
    s_add_u32 s54, s54, s55
    s_lshl_b32 s55, s3, 9
    v_mfma_f32_16x16x32_bf16 v[228:231], v[88:91], a[20:23], v[228:231]
    buffer_load_dwordx4 v24, s[44:47], s67 offen offset:0 lds
    s_waitcnt vmcnt(13)
    s_add_u32 s54, s54, s55
    v_mfma_f32_16x16x32_bf16 v[232:235], v[88:91], a[24:27], v[232:235]
    ds_read_b64_tr_b16 a[96:97], v28 offset:0
    ds_read_b64_tr_b16 a[98:99], v28 offset:2048
    v_mfma_f32_16x16x32_bf16 v[236:239], v[88:91], a[28:31], v[236:239]
    s_waitcnt lgkmcnt(5)
    v_add_u32 v6, s54, v6
    s_and_b32 s54, s84, 12
    v_mfma_f32_16x16x32_bf16 v[240:243], v[92:95], a[16:19], v[240:243]
    ds_read_b128 v[76:79], v15 offset:26624
    s_add_u32 s54, s54, s3
    s_lshl_b32 s54, s54, 7
    v_mfma_f32_16x16x32_bf16 v[244:247], v[92:95], a[20:23], v[244:247]
    s_add_u32 s52, s54, 12623872
    v_and_b32 v56, 15, v0
    v_cvt_f32_u32 v56, v56
    v_mfma_f32_16x16x32_bf16 v[248:251], v[92:95], a[24:27], v[248:251]
    buffer_load_dwordx4 v25, s[44:47], s67 offen offset:1024 lds
    ds_read_b64_tr_b16 a[100:101], v29 offset:0
    v_mfma_f32_16x16x32_bf16 v[252:255], v[92:95], a[28:31], v[252:255]
    s_waitcnt lgkmcnt(6)
    ds_read_b64_tr_b16 a[102:103], v29 offset:2048
    v_mfma_f32_16x16x32_bf16 v[128:131], v[64:67], a[32:35], v[128:131]
    ds_read_b128 v[80:83], v15 offset:34816
    v_fma_f32 v56, v56, 0.5, 0.0
    v_mfma_f32_16x16x32_bf16 v[132:135], v[64:67], a[36:39], v[132:135]
    v_fma_f32 v56, v56, 0.5, 0.0
    v_mul_f32 v56, 0x3e000000, v56
    v_mfma_f32_16x16x32_bf16 v[136:139], v[64:67], a[40:43], v[136:139]
    v_lshrrev_b32 v57, 4, v0
    v_lshlrev_b32 v57, 2, v57
    v_mfma_f32_16x16x32_bf16 v[140:143], v[64:67], a[44:47], v[140:143]
    s_waitcnt lgkmcnt(7)
    buffer_load_dwordx4 v26, s[44:47], s67 offen offset:2048 lds
    v_mfma_f32_16x16x32_bf16 v[144:147], v[68:71], a[32:35], v[144:147]
    ds_read_b128 v[84:87], v15 offset:43008
    ds_read_b64_tr_b16 a[104:105], v30 offset:0
    v_mfma_f32_16x16x32_bf16 v[148:151], v[68:71], a[36:39], v[148:151]
    ds_read_b64_tr_b16 a[106:107], v30 offset:2048
    v_cvt_f32_u32 v57, v57
    v_mfma_f32_16x16x32_bf16 v[152:155], v[68:71], a[40:43], v[152:155]
    v_add_f32 v42, 0x0, v57
    v_add_f32 v43, 0x3f800000, v57
    v_mfma_f32_16x16x32_bf16 v[156:159], v[68:71], a[44:47], v[156:159]
    s_waitcnt lgkmcnt(9)
    v_add_f32 v44, 0x40000000, v57
    v_add_f32 v45, 0x40400000, v57
    v_mfma_f32_16x16x32_bf16 v[160:163], v[72:75], a[32:35], v[160:163]
    ds_read_b128 v[88:91], v15 offset:51200
    buffer_load_dwordx4 v27, s[44:47], s67 offen offset:3072 lds
    v_mfma_f32_16x16x32_bf16 v[164:167], v[72:75], a[36:39], v[164:167]
    ds_read_b64_tr_b16 a[108:109], v31 offset:0
    ds_read_b64_tr_b16 a[110:111], v31 offset:2048
    s_add_u32 m0, s59, 147456
    v_mfma_f32_16x16x32_bf16 v[168:171], v[72:75], a[40:43], v[168:171]
    s_add_u32 s67, s62, 1310720
    v_mul_f32 v42, v56, v42
    v_mul_f32 v43, v56, v43
    v_mfma_f32_16x16x32_bf16 v[172:175], v[72:75], a[44:47], v[172:175]
    s_waitcnt lgkmcnt(9)
    v_mul_f32 v44, v56, v44
    v_mul_f32 v45, v56, v45
    v_mfma_f32_16x16x32_bf16 v[176:179], v[76:79], a[32:35], v[176:179]
    ds_read_b128 v[92:95], v15 offset:59392
    v_fract_f32 v42, v42
    v_mfma_f32_16x16x32_bf16 v[180:183], v[76:79], a[36:39], v[180:183]
    buffer_load_dwordx4 v24, s[44:47], s67 offen offset:0 lds
    s_waitcnt vmcnt(9)
    v_fract_f32 v43, v43
    v_mfma_f32_16x16x32_bf16 v[184:187], v[76:79], a[40:43], v[184:187]
    ds_read_b64_tr_b16 a[112:113], v7 offset:0
    ds_read_b64_tr_b16 a[114:115], v7 offset:2048
    v_mfma_f32_16x16x32_bf16 v[188:191], v[76:79], a[44:47], v[188:191]
    s_waitcnt lgkmcnt(9)
    v_fract_f32 v44, v44
    v_fract_f32 v45, v45
    v_mfma_f32_16x16x32_bf16 v[192:195], v[80:83], a[32:35], v[192:195]
    ds_read_b128 v[64:67], v16 offset:3072
    v_mfma_f32_16x16x32_bf16 v[196:199], v[80:83], a[36:39], v[196:199]
    v_cos_f32 v46, v42
    v_mfma_f32_16x16x32_bf16 v[200:203], v[80:83], a[40:43], v[200:203]
    buffer_load_dwordx4 v25, s[44:47], s67 offen offset:1024 lds
    ds_read_b64_tr_b16 a[116:117], v8 offset:0
    v_mfma_f32_16x16x32_bf16 v[204:207], v[80:83], a[44:47], v[204:207]
    s_waitcnt lgkmcnt(10)
    ds_read_b64_tr_b16 a[118:119], v8 offset:2048
    v_mfma_f32_16x16x32_bf16 v[208:211], v[84:87], a[32:35], v[208:211]
    ds_read_b128 v[68:71], v16 offset:11264
    v_mfma_f32_16x16x32_bf16 v[212:215], v[84:87], a[36:39], v[212:215]
    v_sin_f32 v50, v42
    v_mfma_f32_16x16x32_bf16 v[216:219], v[84:87], a[40:43], v[216:219]
    v_cos_f32 v47, v43
    v_mfma_f32_16x16x32_bf16 v[220:223], v[84:87], a[44:47], v[220:223]
    s_waitcnt lgkmcnt(9)
    buffer_load_dwordx4 v26, s[44:47], s67 offen offset:2048 lds
    v_mfma_f32_16x16x32_bf16 v[224:227], v[88:91], a[32:35], v[224:227]
    ds_read_b128 v[72:75], v16 offset:19456
    ds_read_b64_tr_b16 a[120:121], v9 offset:0
    v_mfma_f32_16x16x32_bf16 v[228:231], v[88:91], a[36:39], v[228:231]
    ds_read_b64_tr_b16 a[122:123], v9 offset:2048
    v_mfma_f32_16x16x32_bf16 v[232:235], v[88:91], a[40:43], v[232:235]
    v_sin_f32 v51, v43
    v_mfma_f32_16x16x32_bf16 v[236:239], v[88:91], a[44:47], v[236:239]
    s_waitcnt lgkmcnt(9)
    v_cos_f32 v48, v44
    v_mfma_f32_16x16x32_bf16 v[240:243], v[92:95], a[32:35], v[240:243]
    ds_read_b128 v[76:79], v16 offset:27648
    buffer_load_dwordx4 v27, s[44:47], s67 offen offset:3072 lds
    v_mfma_f32_16x16x32_bf16 v[244:247], v[92:95], a[36:39], v[244:247]
    ds_read_b64_tr_b16 a[124:125], v10 offset:0
    ds_read_b64_tr_b16 a[126:127], v10 offset:2048
    v_mfma_f32_16x16x32_bf16 v[248:251], v[92:95], a[40:43], v[248:251]
    s_add_u32 m0, s59, 0
    s_add_u32 s67, s62, 1441792
    v_mfma_f32_16x16x32_bf16 v[252:255], v[92:95], a[44:47], v[252:255]
    s_waitcnt lgkmcnt(9)
    v_sin_f32 v52, v44
    v_mfma_f32_16x16x32_bf16 v[128:131], v[64:67], a[48:51], v[128:131]
    ds_read_b128 v[80:83], v16 offset:35840
    buffer_load_dwordx4 v24, s[44:47], s67 offen offset:0 lds
    s_waitcnt vmcnt(9)
    v_mfma_f32_16x16x32_bf16 v[132:135], v[64:67], a[52:55], v[132:135]
    ds_read_b64_tr_b16 a[128:129], v7 offset:16384
    ds_read_b64_tr_b16 a[130:131], v7 offset:18432
    v_mfma_f32_16x16x32_bf16 v[136:139], v[64:67], a[56:59], v[136:139]
    v_cos_f32 v49, v45
    v_mfma_f32_16x16x32_bf16 v[140:143], v[64:67], a[60:63], v[140:143]
    s_waitcnt lgkmcnt(9)
    v_sin_f32 v53, v45
    v_mfma_f32_16x16x32_bf16 v[144:147], v[68:71], a[48:51], v[144:147]
    ds_read_b128 v[84:87], v16 offset:44032
    v_cvt_pk_bf16_f32 v42, v46, v47
    v_mfma_f32_16x16x32_bf16 v[148:151], v[68:71], a[52:55], v[148:151]
    buffer_load_dwordx4 v25, s[44:47], s67 offen offset:1024 lds
    ds_read_b64_tr_b16 a[132:133], v8 offset:16384
    v_mfma_f32_16x16x32_bf16 v[152:155], v[68:71], a[56:59], v[152:155]
    ds_read_b64_tr_b16 a[134:135], v8 offset:18432
    v_cvt_pk_bf16_f32 v44, v50, v51
    v_mfma_f32_16x16x32_bf16 v[156:159], v[68:71], a[60:63], v[156:159]
    s_waitcnt lgkmcnt(11)
    v_cvt_pk_bf16_f32 v43, v48, v49
    v_cvt_pk_bf16_f32 v45, v52, v53
    v_mfma_f32_16x16x32_bf16 v[160:163], v[72:75], a[48:51], v[160:163]
    ds_read_b128 v[88:91], v16 offset:52224
    v_accvgpr_write_b32 a224, v42
    v_mfma_f32_16x16x32_bf16 v[164:167], v[72:75], a[52:55], v[164:167]
    v_accvgpr_write_b32 a232, v44
    v_xor_b32 v42, 0x80008000, v42
    v_mfma_f32_16x16x32_bf16 v[168:171], v[72:75], a[56:59], v[168:171]
    buffer_load_dwordx4 v26, s[44:47], s67 offen offset:2048 lds
    ds_read_b64_tr_b16 a[136:137], v9 offset:16384
    v_mfma_f32_16x16x32_bf16 v[172:175], v[72:75], a[60:63], v[172:175]
    s_waitcnt lgkmcnt(10)
    ds_read_b64_tr_b16 a[138:139], v9 offset:18432
    v_mfma_f32_16x16x32_bf16 v[176:179], v[76:79], a[48:51], v[176:179]
    ds_read_b128 v[92:95], v16 offset:60416
    v_accvgpr_write_b32 a240, v42
    v_mfma_f32_16x16x32_bf16 v[180:183], v[76:79], a[52:55], v[180:183]
    v_accvgpr_write_b32 a225, v43
    v_accvgpr_write_b32 a233, v45
    v_mfma_f32_16x16x32_bf16 v[184:187], v[76:79], a[56:59], v[184:187]
    v_xor_b32 v43, 0x80008000, v43
    v_accvgpr_write_b32 a241, v43
    v_mfma_f32_16x16x32_bf16 v[188:191], v[76:79], a[60:63], v[188:191]
    s_waitcnt lgkmcnt(9)
    buffer_load_dwordx4 v27, s[44:47], s67 offen offset:3072 lds
    v_mfma_f32_16x16x32_bf16 v[192:195], v[80:83], a[48:51], v[192:195]
    ds_read_b128 v[64:67], v15 offset:4096
    ds_read_b64_tr_b16 a[140:141], v10 offset:16384
HD2:
    s_cbranch_execz HBD
    v_mfma_f32_16x16x32_bf16 v[196:199], v[80:83], a[52:55], v[196:199]
    ds_read_b64_tr_b16 a[142:143], v10 offset:18432
    s_add_u32 m0, s59, 98304
    v_mfma_f32_16x16x32_bf16 v[200:203], v[80:83], a[56:59], v[200:203]
    s_add_u32 s67, s62, 1572864
    v_add_f32 v42, 0x41800000, v57
    v_add_f32 v43, 0x41880000, v57
    v_mfma_f32_16x16x32_bf16 v[204:207], v[80:83], a[60:63], v[204:207]
    s_waitcnt lgkmcnt(9)
    v_add_f32 v44, 0x41900000, v57
    v_add_f32 v45, 0x41980000, v57
    v_mfma_f32_16x16x32_bf16 v[208:211], v[84:87], a[48:51], v[208:211]
    ds_read_b128 v[68:71], v15 offset:12288
    buffer_load_dwordx4 v24, s[44:47], s67 offen offset:0 lds
    s_waitcnt vmcnt(9)
    v_mfma_f32_16x16x32_bf16 v[212:215], v[84:87], a[52:55], v[212:215]
    ds_read_b64_tr_b16 a[144:145], v7 offset:32768
    ds_read_b64_tr_b16 a[146:147], v7 offset:34816
    v_mfma_f32_16x16x32_bf16 v[216:219], v[84:87], a[56:59], v[216:219]
    v_mul_f32 v42, v56, v42
    v_mul_f32 v43, v56, v43
    v_mfma_f32_16x16x32_bf16 v[220:223], v[84:87], a[60:63], v[220:223]
    s_waitcnt lgkmcnt(9)
    v_mul_f32 v44, v56, v44
    v_mul_f32 v45, v56, v45
    v_mfma_f32_16x16x32_bf16 v[224:227], v[88:91], a[48:51], v[224:227]
    ds_read_b128 v[72:75], v15 offset:20480
    v_fract_f32 v42, v42
    v_mfma_f32_16x16x32_bf16 v[228:231], v[88:91], a[52:55], v[228:231]
    buffer_load_dwordx4 v25, s[44:47], s67 offen offset:1024 lds
    ds_read_b64_tr_b16 a[148:149], v8 offset:32768
    v_mfma_f32_16x16x32_bf16 v[232:235], v[88:91], a[56:59], v[232:235]
    ds_read_b64_tr_b16 a[150:151], v8 offset:34816
    v_fract_f32 v43, v43
    v_mfma_f32_16x16x32_bf16 v[236:239], v[88:91], a[60:63], v[236:239]
    s_waitcnt lgkmcnt(9)
    v_fract_f32 v44, v44
    v_fract_f32 v45, v45
    v_mfma_f32_16x16x32_bf16 v[240:243], v[92:95], a[48:51], v[240:243]
    ds_read_b128 v[76:79], v15 offset:28672
    v_mfma_f32_16x16x32_bf16 v[244:247], v[92:95], a[52:55], v[244:247]
    v_cos_f32 v46, v42
    v_mfma_f32_16x16x32_bf16 v[248:251], v[92:95], a[56:59], v[248:251]
    buffer_load_dwordx4 v26, s[44:47], s67 offen offset:2048 lds
    ds_read_b64_tr_b16 a[152:153], v9 offset:32768
    v_mfma_f32_16x16x32_bf16 v[252:255], v[92:95], a[60:63], v[252:255]
    s_waitcnt lgkmcnt(10)
    ds_read_b64_tr_b16 a[154:155], v9 offset:34816
    v_mfma_f32_16x16x32_bf16 v[128:131], v[64:67], v[96:99], v[128:131]
    ds_read_b128 v[80:83], v15 offset:36864
    v_mfma_f32_16x16x32_bf16 v[132:135], v[64:67], v[100:103], v[132:135]
    v_sin_f32 v50, v42
    v_mfma_f32_16x16x32_bf16 v[136:139], v[64:67], v[104:107], v[136:139]
    v_cos_f32 v47, v43
    v_mfma_f32_16x16x32_bf16 v[140:143], v[64:67], v[108:111], v[140:143]
    s_waitcnt lgkmcnt(9)
    buffer_load_dwordx4 v27, s[44:47], s67 offen offset:3072 lds
    v_mfma_f32_16x16x32_bf16 v[144:147], v[68:71], v[96:99], v[144:147]
    ds_read_b128 v[84:87], v15 offset:45056
    ds_read_b64_tr_b16 a[156:157], v10 offset:32768
    v_mfma_f32_16x16x32_bf16 v[148:151], v[68:71], v[100:103], v[148:151]
    ds_read_b64_tr_b16 a[158:159], v10 offset:34816
    s_add_u32 m0, s59, 114688
    v_mfma_f32_16x16x32_bf16 v[152:155], v[68:71], v[104:107], v[152:155]
    s_add_u32 s67, s62, 1703936
    v_sin_f32 v51, v43
    v_mfma_f32_16x16x32_bf16 v[156:159], v[68:71], v[108:111], v[156:159]
    s_waitcnt lgkmcnt(9)
    buffer_load_dwordx4 v24, s[44:47], s67 offen offset:0 lds
    s_waitcnt vmcnt(9)
    v_mfma_f32_16x16x32_bf16 v[160:163], v[72:75], v[96:99], v[160:163]
    ds_read_b128 v[88:91], v15 offset:53248
    ds_read_b64_tr_b16 a[160:161], v7 offset:49152
    v_mfma_f32_16x16x32_bf16 v[164:167], v[72:75], v[100:103], v[164:167]
    ds_read_b64_tr_b16 a[162:163], v7 offset:51200
    v_mfma_f32_16x16x32_bf16 v[168:171], v[72:75], v[104:107], v[168:171]
    v_cos_f32 v48, v44
    v_mfma_f32_16x16x32_bf16 v[172:175], v[72:75], v[108:111], v[172:175]
    s_waitcnt lgkmcnt(9)
    v_sin_f32 v52, v44
    v_mfma_f32_16x16x32_bf16 v[176:179], v[76:79], v[96:99], v[176:179]
    ds_read_b128 v[92:95], v15 offset:61440
    buffer_load_dwordx4 v25, s[44:47], s67 offen offset:1024 lds
    v_mfma_f32_16x16x32_bf16 v[180:183], v[76:79], v[100:103], v[180:183]
    ds_read_b64_tr_b16 a[164:165], v8 offset:49152
    ds_read_b64_tr_b16 a[166:167], v8 offset:51200
    v_mfma_f32_16x16x32_bf16 v[184:187], v[76:79], v[104:107], v[184:187]
    v_cos_f32 v49, v45
    v_mfma_f32_16x16x32_bf16 v[188:191], v[76:79], v[108:111], v[188:191]
    s_waitcnt lgkmcnt(9)
    v_sin_f32 v53, v45
    v_mfma_f32_16x16x32_bf16 v[192:195], v[80:83], v[96:99], v[192:195]
    ds_read_b128 v[64:67], v16 offset:5120
    v_cvt_pk_bf16_f32 v42, v46, v47
    v_mfma_f32_16x16x32_bf16 v[196:199], v[80:83], v[100:103], v[196:199]
    buffer_load_dwordx4 v26, s[44:47], s67 offen offset:2048 lds
    ds_read_b64_tr_b16 a[168:169], v9 offset:49152
    v_mfma_f32_16x16x32_bf16 v[200:203], v[80:83], v[104:107], v[200:203]
    ds_read_b64_tr_b16 a[170:171], v9 offset:51200
    v_cvt_pk_bf16_f32 v44, v50, v51
    v_mfma_f32_16x16x32_bf16 v[204:207], v[80:83], v[108:111], v[204:207]
    s_waitcnt lgkmcnt(11)
    v_cvt_pk_bf16_f32 v43, v48, v49
    v_cvt_pk_bf16_f32 v45, v52, v53
    v_mfma_f32_16x16x32_bf16 v[208:211], v[84:87], v[96:99], v[208:211]
    ds_read_b128 v[68:71], v16 offset:13312
    v_accvgpr_write_b32 a226, v42
    v_mfma_f32_16x16x32_bf16 v[212:215], v[84:87], v[100:103], v[212:215]
    v_accvgpr_write_b32 a234, v44
    v_xor_b32 v42, 0x80008000, v42
    v_mfma_f32_16x16x32_bf16 v[216:219], v[84:87], v[104:107], v[216:219]
    buffer_load_dwordx4 v27, s[44:47], s67 offen offset:3072 lds
    ds_read_b64_tr_b16 a[172:173], v10 offset:49152
    v_mfma_f32_16x16x32_bf16 v[220:223], v[84:87], v[108:111], v[220:223]
    s_waitcnt lgkmcnt(10)
    ds_read_b64_tr_b16 a[174:175], v10 offset:51200
    v_mfma_f32_16x16x32_bf16 v[224:227], v[88:91], v[96:99], v[224:227]
    ds_read_b128 v[72:75], v16 offset:21504
    s_add_u32 m0, s59, 131072
    s_add_u32 s67, s64, 0
    v_mfma_f32_16x16x32_bf16 v[228:231], v[88:91], v[100:103], v[228:231]
    v_accvgpr_write_b32 a242, v42
    v_accvgpr_write_b32 a227, v43
    v_mfma_f32_16x16x32_bf16 v[232:235], v[88:91], v[104:107], v[232:235]
    v_accvgpr_write_b32 a235, v45
    v_xor_b32 v43, 0x80008000, v43
    v_mfma_f32_16x16x32_bf16 v[236:239], v[88:91], v[108:111], v[236:239]
    s_waitcnt lgkmcnt(9)
    buffer_load_dwordx4 v24, s[44:47], s67 offen offset:0 lds
    s_waitcnt vmcnt(9)
    v_mfma_f32_16x16x32_bf16 v[240:243], v[92:95], v[96:99], v[240:243]
    ds_read_b128 v[76:79], v16 offset:29696
    ds_read_b64_tr_b16 a[176:177], v28 offset:0
    v_mfma_f32_16x16x32_bf16 v[244:247], v[92:95], v[100:103], v[244:247]
    ds_read_b64_tr_b16 a[178:179], v28 offset:2048
    v_accvgpr_write_b32 a243, v43
    v_mfma_f32_16x16x32_bf16 v[248:251], v[92:95], v[104:107], v[248:251]
    v_and_b32 v56, 15, v0
    v_cvt_f32_u32 v56, v56
    v_mfma_f32_16x16x32_bf16 v[252:255], v[92:95], v[108:111], v[252:255]
    s_waitcnt lgkmcnt(9)
    v_fma_f32 v56, v56, 0.5, 4.0
    v_fma_f32 v56, v56, 0.5, 2.0
    v_mfma_f32_16x16x32_bf16 v[128:131], v[64:67], v[112:115], v[128:131]
    ds_read_b128 v[80:83], v16 offset:37888
    buffer_load_dwordx4 v25, s[44:47], s67 offen offset:1024 lds
    v_mfma_f32_16x16x32_bf16 v[132:135], v[64:67], v[116:119], v[132:135]
    ds_read_b64_tr_b16 a[180:181], v29 offset:0
    ds_read_b64_tr_b16 a[182:183], v29 offset:2048
    v_mfma_f32_16x16x32_bf16 v[136:139], v[64:67], v[120:123], v[136:139]
    v_accvgpr_read_b32 v96, a64
    v_xor_b32 v96, v58, v96
    v_mfma_f32_16x16x32_bf16 v[140:143], v[64:67], v[124:127], v[140:143]
    s_waitcnt lgkmcnt(9)
    v_accvgpr_read_b32 v97, a65
    v_xor_b32 v97, v58, v97
    v_mfma_f32_16x16x32_bf16 v[144:147], v[68:71], v[112:115], v[144:147]
    ds_read_b128 v[84:87], v16 offset:46080
    v_accvgpr_read_b32 v98, a66
    v_mfma_f32_16x16x32_bf16 v[148:151], v[68:71], v[116:119], v[148:151]
    buffer_load_dwordx4 v26, s[44:47], s67 offen offset:2048 lds
    ds_read_b64_tr_b16 a[184:185], v30 offset:0
    v_mfma_f32_16x16x32_bf16 v[152:155], v[68:71], v[120:123], v[152:155]
    ds_read_b64_tr_b16 a[186:187], v30 offset:2048
    v_xor_b32 v98, v58, v98
    v_mfma_f32_16x16x32_bf16 v[156:159], v[68:71], v[124:127], v[156:159]
    s_waitcnt lgkmcnt(9)
    v_accvgpr_read_b32 v99, a67
    v_xor_b32 v99, v58, v99
    v_mfma_f32_16x16x32_bf16 v[160:163], v[72:75], v[112:115], v[160:163]
    ds_read_b128 v[88:91], v16 offset:54272
    v_accvgpr_read_b32 v100, a68
    v_mfma_f32_16x16x32_bf16 v[164:167], v[72:75], v[116:119], v[164:167]
    v_xor_b32 v100, v58, v100
    v_accvgpr_read_b32 v101, a69
    v_mfma_f32_16x16x32_bf16 v[168:171], v[72:75], v[120:123], v[168:171]
    buffer_load_dwordx4 v27, s[44:47], s67 offen offset:3072 lds
    ds_read_b64_tr_b16 a[188:189], v31 offset:0
    v_mfma_f32_16x16x32_bf16 v[172:175], v[72:75], v[124:127], v[172:175]
    s_waitcnt lgkmcnt(10)
    ds_read_b64_tr_b16 a[190:191], v31 offset:2048
    v_mfma_f32_16x16x32_bf16 v[176:179], v[76:79], v[112:115], v[176:179]
    ds_read_b128 v[92:95], v16 offset:62464
    s_add_u32 m0, s59, 147456
    s_add_u32 s67, s64, 131072
    v_mfma_f32_16x16x32_bf16 v[180:183], v[76:79], v[116:119], v[180:183]
    v_xor_b32 v101, v58, v101
    v_accvgpr_read_b32 v102, a70
    v_mfma_f32_16x16x32_bf16 v[184:187], v[76:79], v[120:123], v[184:187]
    buffer_load_dwordx4 v24, s[44:47], s67 offen offset:0 lds
    s_waitcnt vmcnt(9)
    v_xor_b32 v102, v58, v102
    v_mfma_f32_16x16x32_bf16 v[188:191], v[76:79], v[124:127], v[188:191]
    s_waitcnt lgkmcnt(9)
    ds_read_b64_tr_b16 a[192:193], v7 offset:0
    v_mfma_f32_16x16x32_bf16 v[192:195], v[80:83], v[112:115], v[192:195]
    ds_read_b128 v[64:67], v15 offset:6144
    ds_read_b64_tr_b16 a[194:195], v7 offset:2048
    v_mfma_f32_16x16x32_bf16 v[196:199], v[80:83], v[116:119], v[196:199]
    v_accvgpr_read_b32 v103, a71
    v_xor_b32 v103, v58, v103
    v_accvgpr_read_b32 v104, a72
    v_mfma_f32_16x16x32_bf16 v[200:203], v[80:83], v[120:123], v[200:203]
    v_xor_b32 v104, v59, v104
    v_accvgpr_read_b32 v105, a73
    v_mfma_f32_16x16x32_bf16 v[204:207], v[80:83], v[124:127], v[204:207]
    s_waitcnt lgkmcnt(9)
    buffer_load_dwordx4 v25, s[44:47], s67 offen offset:1024 lds
    v_mfma_f32_16x16x32_bf16 v[208:211], v[84:87], v[112:115], v[208:211]
    ds_read_b128 v[68:71], v15 offset:14336
    ds_read_b64_tr_b16 a[196:197], v8 offset:0
    v_mfma_f32_16x16x32_bf16 v[212:215], v[84:87], v[116:119], v[212:215]
    ds_read_b64_tr_b16 a[198:199], v8 offset:2048
    v_xor_b32 v105, v59, v105
    v_mfma_f32_16x16x32_bf16 v[216:219], v[84:87], v[120:123], v[216:219]
    v_accvgpr_read_b32 v106, a74
    v_xor_b32 v106, v59, v106
    v_mfma_f32_16x16x32_bf16 v[220:223], v[84:87], v[124:127], v[220:223]
    s_waitcnt lgkmcnt(9)
    v_accvgpr_read_b32 v107, a75
    v_xor_b32 v107, v59, v107
    v_accvgpr_read_b32 v108, a76
    v_mfma_f32_16x16x32_bf16 v[224:227], v[88:91], v[112:115], v[224:227]
    ds_read_b128 v[72:75], v15 offset:22528
    buffer_load_dwordx4 v26, s[44:47], s67 offen offset:2048 lds
    v_mfma_f32_16x16x32_bf16 v[228:231], v[88:91], v[116:119], v[228:231]
    ds_read_b64_tr_b16 a[200:201], v9 offset:0
    ds_read_b64_tr_b16 a[202:203], v9 offset:2048
    v_mfma_f32_16x16x32_bf16 v[232:235], v[88:91], v[120:123], v[232:235]
    v_xor_b32 v108, v59, v108
    v_accvgpr_read_b32 v109, a77
    v_mfma_f32_16x16x32_bf16 v[236:239], v[88:91], v[124:127], v[236:239]
    s_waitcnt lgkmcnt(9)
    v_xor_b32 v109, v59, v109
    v_accvgpr_read_b32 v110, a78
    v_mfma_f32_16x16x32_bf16 v[240:243], v[92:95], v[112:115], v[240:243]
    ds_read_b128 v[76:79], v15 offset:30720
    v_xor_b32 v110, v59, v110
    v_accvgpr_read_b32 v111, a79
    v_mfma_f32_16x16x32_bf16 v[244:247], v[92:95], v[116:119], v[244:247]
    buffer_load_dwordx4 v27, s[44:47], s67 offen offset:3072 lds
    ds_read_b64_tr_b16 a[204:205], v10 offset:0
    v_xor_b32 v111, v59, v111
    v_mfma_f32_16x16x32_bf16 v[248:251], v[92:95], v[120:123], v[248:251]
    ds_read_b64_tr_b16 a[206:207], v10 offset:2048
    s_add_u32 m0, s59, 0
    v_mfma_f32_16x16x32_bf16 v[252:255], v[92:95], v[124:127], v[252:255]
    s_waitcnt lgkmcnt(10)
    s_add_u32 s67, s64, 262144
    v_mul_f32 v56, 0x3e000000, v56
    v_mfma_f32_16x16x32_bf16 v[128:131], v[64:67], v[96:99], v[128:131]
    ds_read_b128 v[80:83], v15 offset:38912
    v_accvgpr_read_b32 v112, a80
    v_mfma_f32_16x16x32_bf16 v[132:135], v[64:67], v[100:103], v[132:135]
    buffer_load_dwordx4 v24, s[44:47], s67 offen offset:0 lds
    s_waitcnt vmcnt(9)
    v_xor_b32 v112, v58, v112
    v_mfma_f32_16x16x32_bf16 v[136:139], v[64:67], v[104:107], v[136:139]
    ds_read_b64_tr_b16 a[208:209], v7 offset:16384
    ds_read_b64_tr_b16 a[210:211], v7 offset:18432
    v_mfma_f32_16x16x32_bf16 v[140:143], v[64:67], v[108:111], v[140:143]
    s_waitcnt lgkmcnt(11)
    v_accvgpr_read_b32 v113, a81
    v_xor_b32 v113, v58, v113
    v_mfma_f32_16x16x32_bf16 v[144:147], v[68:71], v[96:99], v[144:147]
    ds_read_b128 v[84:87], v15 offset:47104
    v_accvgpr_read_b32 v114, a82
    v_xor_b32 v114, v58, v114
    v_mfma_f32_16x16x32_bf16 v[148:151], v[68:71], v[100:103], v[148:151]
    v_accvgpr_read_b32 v115, a83
    v_xor_b32 v115, v58, v115
    v_mfma_f32_16x16x32_bf16 v[152:155], v[68:71], v[104:107], v[152:155]
    buffer_load_dwordx4 v25, s[44:47], s67 offen offset:1024 lds
    ds_read_b64_tr_b16 a[212:213], v8 offset:16384
    v_mfma_f32_16x16x32_bf16 v[156:159], v[68:71], v[108:111], v[156:159]
    s_waitcnt lgkmcnt(10)
    ds_read_b64_tr_b16 a[214:215], v8 offset:18432
    v_accvgpr_read_b32 v116, a84
    v_mfma_f32_16x16x32_bf16 v[160:163], v[72:75], v[96:99], v[160:163]
    ds_read_b128 v[88:91], v15 offset:55296
    v_xor_b32 v116, v58, v116
    v_mfma_f32_16x16x32_bf16 v[164:167], v[72:75], v[100:103], v[164:167]
    v_accvgpr_read_b32 v117, a85
    v_xor_b32 v117, v58, v117
    v_mfma_f32_16x16x32_bf16 v[168:171], v[72:75], v[104:107], v[168:171]
    buffer_load_dwordx4 v26, s[44:47], s67 offen offset:2048 lds
    ds_read_b64_tr_b16 a[216:217], v9 offset:16384
    ds_read_b64_tr_b16 a[218:219], v9 offset:18432
    v_mfma_f32_16x16x32_bf16 v[172:175], v[72:75], v[108:111], v[172:175]
    s_waitcnt lgkmcnt(11)
    v_accvgpr_read_b32 v118, a86
    v_xor_b32 v118, v58, v118
    v_mfma_f32_16x16x32_bf16 v[176:179], v[76:79], v[96:99], v[176:179]
    ds_read_b128 v[92:95], v15 offset:63488
    v_accvgpr_read_b32 v119, a87
    v_xor_b32 v119, v58, v119
    v_mfma_f32_16x16x32_bf16 v[180:183], v[76:79], v[100:103], v[180:183]
    v_accvgpr_read_b32 v120, a88
    v_xor_b32 v120, v59, v120
    v_mfma_f32_16x16x32_bf16 v[184:187], v[76:79], v[104:107], v[184:187]
    v_accvgpr_read_b32 v121, a89
    v_xor_b32 v121, v59, v121
    v_mfma_f32_16x16x32_bf16 v[188:191], v[76:79], v[108:111], v[188:191]
    s_waitcnt lgkmcnt(9)
    buffer_load_dwordx4 v27, s[44:47], s67 offen offset:3072 lds
    ds_read_b64_tr_b16 a[220:221], v10 offset:16384
    v_mfma_f32_16x16x32_bf16 v[192:195], v[80:83], v[96:99], v[192:195]
    ds_read_b128 v[64:67], v16 offset:7168
    ds_read_b64_tr_b16 a[222:223], v10 offset:18432
    v_mfma_f32_16x16x32_bf16 v[196:199], v[80:83], v[100:103], v[196:199]
    s_add_u32 m0, s59, 98304
    s_add_u32 s67, s64, 393216
    v_accvgpr_read_b32 v122, a90
    v_xor_b32 v122, v59, v122
    v_mfma_f32_16x16x32_bf16 v[200:203], v[80:83], v[104:107], v[200:203]
    v_accvgpr_read_b32 v123, a91
    v_xor_b32 v123, v59, v123
    v_mfma_f32_16x16x32_bf16 v[204:207], v[80:83], v[108:111], v[204:207]
    s_waitcnt lgkmcnt(9)
    buffer_load_dwordx4 v24, s[44:47], s67 offen offset:0 lds
    v_accvgpr_read_b32 v124, a92
    v_mfma_f32_16x16x32_bf16 v[208:211], v[84:87], v[96:99], v[208:211]
    ds_read_b128 v[68:71], v16 offset:15360
    v_xor_b32 v124, v59, v124
    v_mfma_f32_16x16x32_bf16 v[212:215], v[84:87], v[100:103], v[212:215]
    v_accvgpr_read_b32 v125, a93
    v_xor_b32 v125, v59, v125
    v_accvgpr_read_b32 v126, a94
    v_mfma_f32_16x16x32_bf16 v[216:219], v[84:87], v[104:107], v[216:219]
    v_xor_b32 v126, v59, v126
    v_accvgpr_read_b32 v127, a95
    v_mfma_f32_16x16x32_bf16 v[220:223], v[84:87], v[108:111], v[220:223]
    s_waitcnt lgkmcnt(7)
    buffer_load_dwordx4 v25, s[44:47], s67 offen offset:1024 lds
    v_xor_b32 v127, v59, v127
    v_mfma_f32_16x16x32_bf16 v[224:227], v[88:91], v[96:99], v[224:227]
    ds_read_b128 v[72:75], v16 offset:23552
    v_lshrrev_b32 v57, 4, v0
    v_mfma_f32_16x16x32_bf16 v[228:231], v[88:91], v[100:103], v[228:231]
    v_lshlrev_b32 v57, 2, v57
    v_cvt_f32_u32 v57, v57
    v_add_f32 v42, 0x0, v57
    v_mfma_f32_16x16x32_bf16 v[232:235], v[88:91], v[104:107], v[232:235]
    v_add_f32 v43, 0x3f800000, v57
    v_add_f32 v44, 0x40000000, v57
    v_add_f32 v45, 0x40400000, v57
    v_mfma_f32_16x16x32_bf16 v[236:239], v[88:91], v[108:111], v[236:239]
    s_waitcnt lgkmcnt(5)
    buffer_load_dwordx4 v26, s[44:47], s67 offen offset:2048 lds
    v_mfma_f32_16x16x32_bf16 v[240:243], v[92:95], v[96:99], v[240:243]
    ds_read_b128 v[76:79], v16 offset:31744
    v_mul_f32 v42, v56, v42
    v_mul_f32 v43, v56, v43
    v_mfma_f32_16x16x32_bf16 v[244:247], v[92:95], v[100:103], v[244:247]
    v_mul_f32 v44, v56, v44
    v_mul_f32 v45, v56, v45
    v_mfma_f32_16x16x32_bf16 v[248:251], v[92:95], v[104:107], v[248:251]
    v_fract_f32 v42, v42
    v_fract_f32 v43, v43
    v_fract_f32 v44, v44
    v_mfma_f32_16x16x32_bf16 v[252:255], v[92:95], v[108:111], v[252:255]
    s_waitcnt lgkmcnt(4)
    v_fract_f32 v45, v45
    v_mfma_f32_16x16x32_bf16 v[128:131], v[64:67], v[112:115], v[128:131]
    ds_read_b128 v[80:83], v16 offset:39936
    buffer_load_dwordx4 v27, s[44:47], s67 offen offset:3072 lds
    s_waitcnt lgkmcnt(4)
    s_add_u32 m0, s59, 114688
    v_mfma_f32_16x16x32_bf16 v[132:135], v[64:67], v[116:119], v[132:135]
    s_add_u32 s67, s64, 524288
    v_cos_f32 v46, v42
    v_mfma_f32_16x16x32_bf16 v[136:139], v[64:67], v[120:123], v[136:139]
    v_sin_f32 v50, v42
    v_mfma_f32_16x16x32_bf16 v[140:143], v[64:67], v[124:127], v[140:143]
    s_waitcnt lgkmcnt(3)
    v_cos_f32 v47, v43
    v_mfma_f32_16x16x32_bf16 v[144:147], v[68:71], v[112:115], v[144:147]
    ds_read_b128 v[84:87], v16 offset:48128
    buffer_load_dwordx4 v24, s[44:47], s67 offen offset:0 lds
    v_mfma_f32_16x16x32_bf16 v[148:151], v[68:71], v[116:119], v[148:151]
    v_sin_f32 v51, v43
    v_mfma_f32_16x16x32_bf16 v[152:155], v[68:71], v[120:123], v[152:155]
    v_cos_f32 v48, v44
    v_mfma_f32_16x16x32_bf16 v[156:159], v[68:71], v[124:127], v[156:159]
    s_waitcnt lgkmcnt(3)
    v_sin_f32 v52, v44
    v_mfma_f32_16x16x32_bf16 v[160:163], v[72:75], v[112:115], v[160:163]
    ds_read_b128 v[88:91], v16 offset:56320
    v_cos_f32 v49, v45
    v_mfma_f32_16x16x32_bf16 v[164:167], v[72:75], v[116:119], v[164:167]
    buffer_load_dwordx4 v25, s[44:47], s67 offen offset:1024 lds
    v_sin_f32 v53, v45
    v_mfma_f32_16x16x32_bf16 v[168:171], v[72:75], v[120:123], v[168:171]
    v_cvt_pk_bf16_f32 v42, v46, v47
    v_cvt_pk_bf16_f32 v44, v50, v51
    v_cvt_pk_bf16_f32 v43, v48, v49
    v_mfma_f32_16x16x32_bf16 v[172:175], v[72:75], v[124:127], v[172:175]
    s_waitcnt lgkmcnt(3)
    v_cvt_pk_bf16_f32 v45, v52, v53
    v_accvgpr_write_b32 a228, v42
    v_accvgpr_write_b32 a236, v44
    v_mfma_f32_16x16x32_bf16 v[176:179], v[76:79], v[112:115], v[176:179]
    ds_read_b128 v[92:95], v16 offset:64512
    v_xor_b32 v42, 0x80008000, v42
    v_accvgpr_write_b32 a244, v42
    v_mfma_f32_16x16x32_bf16 v[180:183], v[76:79], v[116:119], v[180:183]
    buffer_load_dwordx4 v26, s[44:47], s67 offen offset:2048 lds
    v_accvgpr_write_b32 a229, v43
    v_mfma_f32_16x16x32_bf16 v[184:187], v[76:79], v[120:123], v[184:187]
    v_accvgpr_write_b32 a237, v45
    v_xor_b32 v43, 0x80008000, v43
    v_accvgpr_write_b32 a245, v43
    v_mfma_f32_16x16x32_bf16 v[188:191], v[76:79], v[124:127], v[188:191]
    s_waitcnt lgkmcnt(3)
    v_add_f32 v42, 0x41800000, v57
    v_add_f32 v43, 0x41880000, v57
    v_add_f32 v44, 0x41900000, v57
    v_mfma_f32_16x16x32_bf16 v[192:195], v[80:83], v[112:115], v[192:195]
    v_add_f32 v45, 0x41980000, v57
    v_mul_f32 v42, v56, v42
    v_mul_f32 v43, v56, v43
    v_mfma_f32_16x16x32_bf16 v[196:199], v[80:83], v[116:119], v[196:199]
    buffer_load_dwordx4 v27, s[44:47], s67 offen offset:3072 lds
    v_mul_f32 v44, v56, v44
    v_mul_f32 v45, v56, v45
    v_mfma_f32_16x16x32_bf16 v[200:203], v[80:83], v[120:123], v[200:203]
    v_fract_f32 v42, v42
    v_fract_f32 v43, v43
    v_mfma_f32_16x16x32_bf16 v[204:207], v[80:83], v[124:127], v[204:207]
    s_waitcnt lgkmcnt(2)
    v_fract_f32 v44, v44
    v_fract_f32 v45, v45
    v_mfma_f32_16x16x32_bf16 v[208:211], v[84:87], v[112:115], v[208:211]
    v_cos_f32 v46, v42
    v_mfma_f32_16x16x32_bf16 v[212:215], v[84:87], v[116:119], v[212:215]
    v_sin_f32 v50, v42
    v_mfma_f32_16x16x32_bf16 v[216:219], v[84:87], v[120:123], v[216:219]
    v_cos_f32 v47, v43
    v_sin_f32 v51, v43
    v_mfma_f32_16x16x32_bf16 v[220:223], v[84:87], v[124:127], v[220:223]
    s_waitcnt lgkmcnt(1)
    v_cos_f32 v48, v44
    v_mfma_f32_16x16x32_bf16 v[224:227], v[88:91], v[112:115], v[224:227]
    v_sin_f32 v52, v44
    v_mfma_f32_16x16x32_bf16 v[228:231], v[88:91], v[116:119], v[228:231]
    v_cos_f32 v49, v45
    v_sin_f32 v53, v45
    v_mfma_f32_16x16x32_bf16 v[232:235], v[88:91], v[120:123], v[232:235]
    v_cvt_pk_bf16_f32 v42, v46, v47
    v_cvt_pk_bf16_f32 v44, v50, v51
    v_cvt_pk_bf16_f32 v43, v48, v49
    v_mfma_f32_16x16x32_bf16 v[236:239], v[88:91], v[124:127], v[236:239]
    s_waitcnt lgkmcnt(0)
    v_cvt_pk_bf16_f32 v45, v52, v53
    v_accvgpr_write_b32 a230, v42
    v_mfma_f32_16x16x32_bf16 v[240:243], v[92:95], v[112:115], v[240:243]
    v_accvgpr_write_b32 a238, v44
    v_xor_b32 v42, 0x80008000, v42
    v_accvgpr_write_b32 a246, v42
    v_mfma_f32_16x16x32_bf16 v[244:247], v[92:95], v[116:119], v[244:247]
    s_barrier
    s_lshl_b32 s67, s3, 11
    s_add_u32 m0, s67, 16384
    s_sub_u32 s67, s82, 1024
    v_mfma_f32_16x16x32_bf16 v[248:251], v[92:95], v[120:123], v[248:251]
    buffer_load_dwordx4 v19, s[28:31], s80 offen lds
    v_accvgpr_write_b32 a231, v43
    v_accvgpr_write_b32 a239, v45
    v_xor_b32 v43, 0x80008000, v43
    v_accvgpr_write_b32 a247, v43
    v_mfma_f32_16x16x32_bf16 v[252:255], v[92:95], v[124:127], v[252:255]
    v_add_u32 v44, 65536, v28
    v_add_u32 v45, 65536, v29
    v_add_u32 v46, 65536, v30
    v_add_u32 v47, 65536, v31
    v_cvt_pk_bf16_f32 v96, v128, v129
    v_cvt_pk_bf16_f32 v97, v130, v131
    v_cvt_pk_bf16_f32 v98, v144, v145
    v_cvt_pk_bf16_f32 v99, v146, v147
    v_cvt_pk_bf16_f32 v100, v136, v137
    v_cvt_pk_bf16_f32 v101, v138, v139
    v_cvt_pk_bf16_f32 v102, v152, v153
    v_cvt_pk_bf16_f32 v103, v154, v155
    v_mfma_f32_16x16x32_bf16 v[128:131], a[224:227], v[96:99], 0
    buffer_load_dwordx4 v19, s[28:31], s67 offen offset:1024 lds
    v_cvt_pk_bf16_f32 v104, v160, v161
    v_mfma_f32_16x16x32_bf16 v[136:139], a[232:235], v[96:99], 0
    v_cvt_pk_bf16_f32 v105, v162, v163
    v_cvt_pk_bf16_f32 v106, v176, v177
    v_mfma_f32_16x16x32_bf16 v[128:131], a[232:235], v[100:103], v[128:131]
    v_cvt_pk_bf16_f32 v107, v178, v179
    v_cvt_pk_bf16_f32 v108, v168, v169
    v_cvt_pk_bf16_f32 v109, v170, v171
    v_mfma_f32_16x16x32_bf16 v[136:139], a[240:243], v[100:103], v[136:139]
    v_cvt_pk_bf16_f32 v110, v184, v185
    v_cvt_pk_bf16_f32 v111, v186, v187
    v_mfma_f32_16x16x32_bf16 v[160:163], a[224:227], v[104:107], 0
    v_cvt_pk_bf16_f32 v112, v192, v193
    v_cvt_pk_bf16_f32 v113, v194, v195
    v_mfma_f32_16x16x32_bf16 v[168:171], a[232:235], v[104:107], 0
    v_cvt_pk_bf16_f32 v114, v208, v209
    v_cvt_pk_bf16_f32 v115, v210, v211
    v_mfma_f32_16x16x32_bf16 v[160:163], a[232:235], v[108:111], v[160:163]
    v_cvt_pk_bf16_f32 v116, v200, v201
    v_cvt_pk_bf16_f32 v117, v202, v203
    v_mfma_f32_16x16x32_bf16 v[168:171], a[240:243], v[108:111], v[168:171]
    v_cvt_pk_bf16_f32 v118, v216, v217
    v_cvt_pk_bf16_f32 v119, v218, v219
    v_mfma_f32_16x16x32_bf16 v[192:195], a[224:227], v[112:115], 0
    v_cvt_pk_bf16_f32 v120, v224, v225
    v_cvt_pk_bf16_f32 v121, v226, v227
    v_cvt_pk_bf16_f32 v122, v240, v241
    v_mfma_f32_16x16x32_bf16 v[200:203], a[232:235], v[112:115], 0
    v_cvt_pk_bf16_f32 v123, v242, v243
    v_cvt_pk_bf16_f32 v124, v232, v233
    v_cvt_pk_bf16_f32 v125, v234, v235
    v_mfma_f32_16x16x32_bf16 v[192:195], a[232:235], v[116:119], v[192:195]
    v_cvt_pk_bf16_f32 v126, v248, v249
    v_cvt_pk_bf16_f32 v127, v250, v251
    v_cvt_pk_bf16_f32 v64, v128, v136
    v_mfma_f32_16x16x32_bf16 v[200:203], a[240:243], v[116:119], v[200:203]
    v_cvt_pk_bf16_f32 v68, v129, v137
    v_cvt_pk_bf16_f32 v72, v130, v138
    v_cvt_pk_bf16_f32 v76, v131, v139
    v_mfma_f32_16x16x32_bf16 v[224:227], a[224:227], v[120:123], 0
    v_cvt_pk_bf16_f32 v65, v160, v168
    v_cvt_pk_bf16_f32 v69, v161, v169
    v_mfma_f32_16x16x32_bf16 v[232:235], a[232:235], v[120:123], 0
    v_cvt_pk_bf16_f32 v73, v162, v170
    v_cvt_pk_bf16_f32 v77, v163, v171
    v_mfma_f32_16x16x32_bf16 v[224:227], a[232:235], v[124:127], v[224:227]
    v_mfma_f32_16x16x32_bf16 v[232:235], a[240:243], v[124:127], v[232:235]
    v_mfma_f32_16x16x32_bf16 v[144:147], a[228:231], v[96:99], 0
    v_cvt_pk_bf16_f32 v66, v192, v200
    v_cvt_pk_bf16_f32 v70, v193, v201
    v_mfma_f32_16x16x32_bf16 v[152:155], a[236:239], v[96:99], 0
    v_cvt_pk_bf16_f32 v74, v194, v202
    v_cvt_pk_bf16_f32 v78, v195, v203
    v_mfma_f32_16x16x32_bf16 v[144:147], a[236:239], v[100:103], v[144:147]
    v_mfma_f32_16x16x32_bf16 v[152:155], a[244:247], v[100:103], v[152:155]
    v_mfma_f32_16x16x32_bf16 v[176:179], a[228:231], v[104:107], 0
    v_cvt_pk_bf16_f32 v67, v224, v232
    v_cvt_pk_bf16_f32 v71, v225, v233
    v_mfma_f32_16x16x32_bf16 v[184:187], a[236:239], v[104:107], 0
    v_cvt_pk_bf16_f32 v75, v226, v234
    v_cvt_pk_bf16_f32 v79, v227, v235
    v_mfma_f32_16x16x32_bf16 v[176:179], a[236:239], v[108:111], v[176:179]
    v_mfma_f32_16x16x32_bf16 v[184:187], a[244:247], v[108:111], v[184:187]
    v_mfma_f32_16x16x32_bf16 v[208:211], a[228:231], v[112:115], 0
    s_mov_b32 s54, 8388608
    buffer_store_dwordx4 v[64:67], v6, s[40:43], s54 offen offset:0 sc1
    v_mfma_f32_16x16x32_bf16 v[216:219], a[236:239], v[112:115], 0
    s_nop 0
    s_mov_b32 s54, 8454144
    buffer_store_dwordx4 v[68:71], v6, s[40:43], s54 offen offset:0 sc1
    v_mfma_f32_16x16x32_bf16 v[208:211], a[236:239], v[116:119], v[208:211]
    s_nop 0
    s_mov_b32 s54, 8519680
    v_cvt_pk_bf16_f32 v80, v144, v152
    v_cvt_pk_bf16_f32 v84, v145, v153
    v_mfma_f32_16x16x32_bf16 v[216:219], a[244:247], v[116:119], v[216:219]
    v_cvt_pk_bf16_f32 v88, v146, v154
    v_cvt_pk_bf16_f32 v92, v147, v155
    v_mfma_f32_16x16x32_bf16 v[240:243], a[228:231], v[120:123], 0
    buffer_store_dwordx4 v[72:75], v6, s[40:43], s54 offen offset:0 sc1
    v_mfma_f32_16x16x32_bf16 v[248:251], a[236:239], v[120:123], 0
    s_nop 0
    s_mov_b32 s54, 8585216
    v_cvt_pk_bf16_f32 v81, v176, v184
    v_cvt_pk_bf16_f32 v85, v177, v185
    v_mfma_f32_16x16x32_bf16 v[240:243], a[236:239], v[124:127], v[240:243]
    v_cvt_pk_bf16_f32 v89, v178, v186
    v_cvt_pk_bf16_f32 v93, v179, v187
    v_cvt_pk_bf16_f32 v128, v132, v133
    v_cvt_pk_bf16_f32 v129, v134, v135
    v_cvt_pk_bf16_f32 v130, v148, v149
    v_cvt_pk_bf16_f32 v131, v150, v151
    v_mfma_f32_16x16x32_bf16 v[248:251], a[244:247], v[124:127], v[248:251]
    buffer_store_dwordx4 v[76:79], v6, s[40:43], s54 offen offset:0 sc1
HD3:
    s_cbranch_execz HBD
    v_cvt_pk_bf16_f32 v136, v140, v141
    v_cvt_pk_bf16_f32 v137, v142, v143
    v_cvt_pk_bf16_f32 v138, v156, v157
    v_cvt_pk_bf16_f32 v139, v158, v159
    v_mfma_f32_16x16x32_bf16 v[132:135], a[224:227], v[128:131], 0
    v_cvt_pk_bf16_f32 v82, v208, v216
    v_cvt_pk_bf16_f32 v86, v209, v217
    v_cvt_pk_bf16_f32 v90, v210, v218
    v_mfma_f32_16x16x32_bf16 v[140:143], a[232:235], v[128:131], 0
    v_cvt_pk_bf16_f32 v94, v211, v219
    v_cvt_pk_bf16_f32 v160, v164, v165
    v_cvt_pk_bf16_f32 v161, v166, v167
    v_mfma_f32_16x16x32_bf16 v[132:135], a[232:235], v[136:139], v[132:135]
    v_cvt_pk_bf16_f32 v162, v180, v181
    v_cvt_pk_bf16_f32 v163, v182, v183
    v_cvt_pk_bf16_f32 v168, v172, v173
    v_mfma_f32_16x16x32_bf16 v[140:143], a[240:243], v[136:139], v[140:143]
    v_cvt_pk_bf16_f32 v169, v174, v175
    v_cvt_pk_bf16_f32 v170, v188, v189
    v_cvt_pk_bf16_f32 v171, v190, v191
    v_mfma_f32_16x16x32_bf16 v[164:167], a[224:227], v[160:163], 0
    v_cvt_pk_bf16_f32 v83, v240, v248
    v_cvt_pk_bf16_f32 v87, v241, v249
    v_cvt_pk_bf16_f32 v91, v242, v250
    v_mfma_f32_16x16x32_bf16 v[172:175], a[232:235], v[160:163], 0
    v_cvt_pk_bf16_f32 v95, v243, v251
    v_cvt_pk_bf16_f32 v192, v196, v197
    v_cvt_pk_bf16_f32 v193, v198, v199
    v_mfma_f32_16x16x32_bf16 v[164:167], a[232:235], v[168:171], v[164:167]
    v_cvt_pk_bf16_f32 v194, v212, v213
    v_cvt_pk_bf16_f32 v195, v214, v215
    v_cvt_pk_bf16_f32 v200, v204, v205
    v_mfma_f32_16x16x32_bf16 v[172:175], a[240:243], v[168:171], v[172:175]
    v_cvt_pk_bf16_f32 v201, v206, v207
    v_cvt_pk_bf16_f32 v202, v220, v221
    v_cvt_pk_bf16_f32 v203, v222, v223
    v_mfma_f32_16x16x32_bf16 v[196:199], a[224:227], v[192:195], 0
    s_mov_b32 s54, 9437184
    buffer_store_dwordx4 v[80:83], v6, s[40:43], s54 offen offset:0 sc1
    v_mfma_f32_16x16x32_bf16 v[204:207], a[232:235], v[192:195], 0
    s_nop 0
    s_mov_b32 s54, 9502720
    buffer_store_dwordx4 v[84:87], v6, s[40:43], s54 offen offset:0 sc1
    v_mfma_f32_16x16x32_bf16 v[196:199], a[232:235], v[200:203], v[196:199]
    s_nop 0
    s_mov_b32 s54, 9568256
    v_cvt_pk_bf16_f32 v96, v132, v140
    v_cvt_pk_bf16_f32 v100, v133, v141
    v_cvt_pk_bf16_f32 v104, v134, v142
    v_cvt_pk_bf16_f32 v108, v135, v143
    v_mfma_f32_16x16x32_bf16 v[204:207], a[240:243], v[200:203], v[204:207]
    buffer_store_dwordx4 v[88:91], v6, s[40:43], s54 offen offset:0 sc1
    s_nop 1
    s_mov_b32 s54, 9633792
    v_cvt_pk_bf16_f32 v224, v228, v229
    v_cvt_pk_bf16_f32 v225, v230, v231
    v_cvt_pk_bf16_f32 v226, v244, v245
    v_cvt_pk_bf16_f32 v227, v246, v247
    v_cvt_pk_bf16_f32 v232, v236, v237
    v_cvt_pk_bf16_f32 v233, v238, v239
    v_cvt_pk_bf16_f32 v234, v252, v253
    v_cvt_pk_bf16_f32 v235, v254, v255
    v_mfma_f32_16x16x32_bf16 v[228:231], a[224:227], v[224:227], 0
    v_cvt_pk_bf16_f32 v97, v164, v172
    v_cvt_pk_bf16_f32 v101, v165, v173
    v_mfma_f32_16x16x32_bf16 v[236:239], a[232:235], v[224:227], 0
    buffer_store_dwordx4 v[92:95], v6, s[40:43], s54 offen offset:0 sc1
    v_mfma_f32_16x16x32_bf16 v[228:231], a[232:235], v[232:235], v[228:231]
    v_cvt_pk_bf16_f32 v105, v166, v174
    v_cvt_pk_bf16_f32 v109, v167, v175
    v_mfma_f32_16x16x32_bf16 v[236:239], a[240:243], v[232:235], v[236:239]
    v_mfma_f32_16x16x32_bf16 v[148:151], a[228:231], v[128:131], 0
    v_cvt_pk_bf16_f32 v98, v196, v204
    v_cvt_pk_bf16_f32 v102, v197, v205
    v_mfma_f32_16x16x32_bf16 v[156:159], a[236:239], v[128:131], 0
    v_cvt_pk_bf16_f32 v106, v198, v206
    v_cvt_pk_bf16_f32 v110, v199, v207
    v_mfma_f32_16x16x32_bf16 v[148:151], a[236:239], v[136:139], v[148:151]
    v_mfma_f32_16x16x32_bf16 v[156:159], a[244:247], v[136:139], v[156:159]
    v_mfma_f32_16x16x32_bf16 v[180:183], a[228:231], v[160:163], 0
    v_cvt_pk_bf16_f32 v99, v228, v236
    v_cvt_pk_bf16_f32 v103, v229, v237
    v_mfma_f32_16x16x32_bf16 v[188:191], a[236:239], v[160:163], 0
    v_cvt_pk_bf16_f32 v107, v230, v238
    v_cvt_pk_bf16_f32 v111, v231, v239
    v_mfma_f32_16x16x32_bf16 v[180:183], a[236:239], v[168:171], v[180:183]
    v_mfma_f32_16x16x32_bf16 v[188:191], a[244:247], v[168:171], v[188:191]
    v_mfma_f32_16x16x32_bf16 v[212:215], a[228:231], v[192:195], 0
    s_mov_b32 s54, 8388608
    buffer_store_dwordx4 v[96:99], v6, s[40:43], s54 offen offset:256 sc1
    v_mfma_f32_16x16x32_bf16 v[220:223], a[236:239], v[192:195], 0
    s_nop 0
    s_mov_b32 s54, 8454144
    buffer_store_dwordx4 v[100:103], v6, s[40:43], s54 offen offset:256 sc1
    v_mfma_f32_16x16x32_bf16 v[212:215], a[236:239], v[200:203], v[212:215]
    s_nop 0
    s_mov_b32 s54, 8519680
    v_cvt_pk_bf16_f32 v112, v148, v156
    v_cvt_pk_bf16_f32 v116, v149, v157
    v_mfma_f32_16x16x32_bf16 v[220:223], a[244:247], v[200:203], v[220:223]
    v_cvt_pk_bf16_f32 v120, v150, v158
    v_cvt_pk_bf16_f32 v124, v151, v159
    v_mfma_f32_16x16x32_bf16 v[244:247], a[228:231], v[224:227], 0
    buffer_store_dwordx4 v[104:107], v6, s[40:43], s54 offen offset:256 sc1
    v_mfma_f32_16x16x32_bf16 v[252:255], a[236:239], v[224:227], 0
    s_nop 0
    s_mov_b32 s54, 8585216
    v_cvt_pk_bf16_f32 v113, v180, v188
    v_cvt_pk_bf16_f32 v117, v181, v189
    v_mfma_f32_16x16x32_bf16 v[244:247], a[236:239], v[232:235], v[244:247]
    v_cvt_pk_bf16_f32 v121, v182, v190
    v_cvt_pk_bf16_f32 v125, v183, v191
    v_mfma_f32_16x16x32_bf16 v[252:255], a[244:247], v[232:235], v[252:255]
    buffer_store_dwordx4 v[108:111], v6, s[40:43], s54 offen offset:256 sc1
    v_cvt_pk_bf16_f32 v114, v212, v220
    v_cvt_pk_bf16_f32 v118, v213, v221
    v_cvt_pk_bf16_f32 v122, v214, v222
    v_cvt_pk_bf16_f32 v126, v215, v223
    s_nop 2
    v_cvt_pk_bf16_f32 v115, v244, v252
    v_cvt_pk_bf16_f32 v119, v245, v253
    v_cvt_pk_bf16_f32 v123, v246, v254
    v_cvt_pk_bf16_f32 v127, v247, v255
    s_mov_b32 s54, 9437184
    buffer_store_dwordx4 v[112:115], v6, s[40:43], s54 offen offset:256 sc1
    s_nop 1
    s_mov_b32 s54, 9502720
    buffer_store_dwordx4 v[116:119], v6, s[40:43], s54 offen offset:256 sc1
    s_nop 1
    s_mov_b32 s54, 9568256
    buffer_store_dwordx4 v[120:123], v6, s[40:43], s54 offen offset:256 sc1
    s_nop 1
    s_mov_b32 s54, 9633792
    buffer_store_dwordx4 v[124:127], v6, s[40:43], s54 offen offset:256 sc1
    s_mov_b32 s57, 0
    s_load_dword s57, s[26:27], s53 offset:0
    ds_read_b64_tr_b16 v[192:193], v44 offset:16384
    ds_read_b64_tr_b16 v[194:195], v44 offset:18432
    ds_read_b64_tr_b16 v[196:197], v45 offset:16384
    ds_read_b64_tr_b16 v[198:199], v45 offset:18432
    ds_read_b64_tr_b16 v[200:201], v46 offset:16384
    ds_read_b64_tr_b16 v[202:203], v46 offset:18432
    ds_read_b64_tr_b16 v[204:205], v47 offset:16384
    ds_read_b64_tr_b16 v[206:207], v47 offset:18432
    s_waitcnt vmcnt(34)
    ds_read_b64_tr_b16 v[80:81], v7 offset:32768
    ds_read_b64_tr_b16 v[82:83], v7 offset:34816
    ds_read_b64_tr_b16 v[84:85], v8 offset:32768
    ds_read_b64_tr_b16 v[86:87], v8 offset:34816
    ds_read_b64_tr_b16 v[88:89], v9 offset:32768
    ds_read_b64_tr_b16 v[90:91], v9 offset:34816
    ds_read_b64_tr_b16 v[92:93], v10 offset:32768
    ds_read_b64_tr_b16 v[94:95], v10 offset:34816
    s_waitcnt vmcnt(30)
    ds_read_b64_tr_b16 v[96:97], v7 offset:49152
    ds_read_b64_tr_b16 v[98:99], v7 offset:51200
    ds_read_b64_tr_b16 v[100:101], v8 offset:49152
    ds_read_b64_tr_b16 v[102:103], v8 offset:51200
    ds_read_b64_tr_b16 v[104:105], v9 offset:49152
    ds_read_b64_tr_b16 v[106:107], v9 offset:51200
    ds_read_b64_tr_b16 v[108:109], v10 offset:49152
    ds_read_b64_tr_b16 v[110:111], v10 offset:51200
    s_waitcnt vmcnt(26)
    ds_read_b64_tr_b16 v[112:113], v28 offset:0
    ds_read_b64_tr_b16 v[114:115], v28 offset:2048
    ds_read_b64_tr_b16 v[116:117], v29 offset:0
    ds_read_b64_tr_b16 v[118:119], v29 offset:2048
    ds_read_b64_tr_b16 v[120:121], v30 offset:0
    ds_read_b64_tr_b16 v[122:123], v30 offset:2048
    ds_read_b64_tr_b16 v[124:125], v31 offset:0
    ds_read_b64_tr_b16 v[126:127], v31 offset:2048
    s_waitcnt vmcnt(0)
    s_atomic_add s58, s[26:27], s52
    s_cmp_ge_u32 s57, 14
    s_cbranch_scc0 SL_q0d
BK_q0d:
    s_add_u32 s68, s66, 0
    buffer_load_dwordx4 a[0:3], v17, s[40:43], s68 offen offset:0 sc1
    buffer_load_dwordx4 a[4:7], v17, s[40:43], s68 offen offset:1024 sc1
    buffer_load_dwordx4 a[8:11], v17, s[40:43], s68 offen offset:2048 sc1
    buffer_load_dwordx4 a[12:15], v17, s[40:43], s68 offen offset:3072 sc1
    s_add_u32 s68, s66, 4096
    buffer_load_dwordx4 a[16:19], v17, s[40:43], s68 offen offset:0 sc1
    buffer_load_dwordx4 a[20:23], v17, s[40:43], s68 offen offset:1024 sc1
    s_mov_b32 s57, 0
    s_load_dword s57, s[26:27], s53 offset:128
    buffer_load_dwordx4 a[24:27], v17, s[40:43], s68 offen offset:2048 sc1
    s_add_u32 s68, s63, 7168
    buffer_load_dwordx4 a[28:31], v17, s[40:43], s68 offen offset:0 sc1
    buffer_load_dwordx4 a[32:35], v17, s[40:43], s68 offen offset:1024 sc1
    buffer_load_dwordx4 a[36:39], v17, s[40:43], s68 offen offset:2048 sc1
    ds_read_b64_tr_b16 v[128:129], v7 offset:0
    ds_read_b64_tr_b16 v[130:131], v7 offset:2048
    ds_read_b64_tr_b16 v[132:133], v8 offset:0
    ds_read_b64_tr_b16 v[134:135], v8 offset:2048
    ds_read_b64_tr_b16 v[136:137], v9 offset:0
    ds_read_b64_tr_b16 v[138:139], v9 offset:2048
    ds_read_b64_tr_b16 v[140:141], v10 offset:0
    ds_read_b64_tr_b16 v[142:143], v10 offset:2048
    ds_read_b64_tr_b16 v[160:161], v7 offset:16384
    ds_read_b64_tr_b16 v[162:163], v7 offset:18432
    ds_read_b64_tr_b16 v[164:165], v8 offset:16384
    ds_read_b64_tr_b16 v[166:167], v8 offset:18432
    ds_read_b64_tr_b16 v[168:169], v9 offset:16384
    ds_read_b64_tr_b16 v[170:171], v9 offset:18432
    ds_read_b64_tr_b16 v[172:173], v10 offset:16384
    ds_read_b64_tr_b16 v[174:175], v10 offset:18432
    ds_read_u8 v21, v0
    ds_read_u8 v21, v0
    ds_read_u8 v21, v0
    s_waitcnt vmcnt(9) lgkmcnt(15)
    v_mfma_f32_16x16x32_bf16 v[144:147], v[80:83], a[0:3], 0
    v_mfma_f32_16x16x32_bf16 v[148:151], v[84:87], a[0:3], 0
    buffer_load_dwordx4 a[40:43], v17, s[40:43], s68 offen offset:3072 sc1
    v_mfma_f32_16x16x32_bf16 v[152:155], v[88:91], a[0:3], 0
    v_mfma_f32_16x16x32_bf16 v[156:159], v[92:95], a[0:3], 0
    s_waitcnt vmcnt(9)
    v_mfma_f32_16x16x32_bf16 v[144:147], v[96:99], a[4:7], v[144:147]
    v_mfma_f32_16x16x32_bf16 v[148:151], v[100:103], a[4:7], v[148:151]
    s_add_u32 s68, s63, 11264
    buffer_load_dwordx4 a[44:47], v17, s[40:43], s68 offen offset:0 sc1
    v_mfma_f32_16x16x32_bf16 v[152:155], v[104:107], a[4:7], v[152:155]
    v_mfma_f32_16x16x32_bf16 v[156:159], v[108:111], a[4:7], v[156:159]
    s_waitcnt vmcnt(9)
    v_mfma_f32_16x16x32_bf16 v[144:147], v[112:115], a[8:11], v[144:147]
    v_mfma_f32_16x16x32_bf16 v[148:151], v[116:119], a[8:11], v[148:151]
    buffer_load_dwordx4 a[48:51], v17, s[40:43], s68 offen offset:1024 sc1
    v_mfma_f32_16x16x32_bf16 v[152:155], v[120:123], a[8:11], v[152:155]
    v_mfma_f32_16x16x32_bf16 v[156:159], v[124:127], a[8:11], v[156:159]
    s_waitcnt vmcnt(9) lgkmcnt(8)
    v_mfma_f32_16x16x32_bf16 v[144:147], v[128:131], a[12:15], v[144:147]
    v_mfma_f32_16x16x32_bf16 v[148:151], v[132:135], a[12:15], v[148:151]
    buffer_load_dwordx4 a[52:55], v17, s[40:43], s68 offen offset:2048 sc1
    v_mfma_f32_16x16x32_bf16 v[152:155], v[136:139], a[12:15], v[152:155]
    v_mfma_f32_16x16x32_bf16 v[156:159], v[140:143], a[12:15], v[156:159]
    s_waitcnt vmcnt(9) lgkmcnt(3)
    v_mfma_f32_16x16x32_bf16 v[144:147], v[160:163], a[16:19], v[144:147]
    s_cmp_ge_u32 s57, 14
    s_cbranch_scc0 SL_q1d
BK_q1d:
    v_mfma_f32_16x16x32_bf16 v[148:151], v[164:167], a[16:19], v[148:151]
    s_add_u32 s68, s66, 57344
    buffer_load_dwordx4 a[0:3], v17, s[40:43], s68 offen offset:0 sc1
    v_mfma_f32_16x16x32_bf16 v[152:155], v[168:171], a[16:19], v[152:155]
    v_mfma_f32_16x16x32_bf16 v[156:159], v[172:175], a[16:19], v[156:159]
    s_waitcnt vmcnt(9)
    v_mfma_f32_16x16x32_bf16 v[144:147], v[192:195], a[20:23], v[144:147]
    v_mfma_f32_16x16x32_bf16 v[148:151], v[196:199], a[20:23], v[148:151]
    buffer_load_dwordx4 a[4:7], v17, s[40:43], s68 offen offset:1024 sc1
    v_mfma_f32_16x16x32_bf16 v[152:155], v[200:203], a[20:23], v[152:155]
    v_mfma_f32_16x16x32_bf16 v[156:159], v[204:207], a[20:23], v[156:159]
    s_waitcnt vmcnt(9)
    v_mfma_f32_16x16x32_bf16 v[144:147], a[96:99], a[24:27], v[144:147]
    v_mfma_f32_16x16x32_bf16 v[148:151], a[100:103], a[24:27], v[148:151]
    buffer_load_dwordx4 a[8:11], v17, s[40:43], s68 offen offset:2048 sc1
    v_mfma_f32_16x16x32_bf16 v[152:155], a[104:107], a[24:27], v[152:155]
    v_mfma_f32_16x16x32_bf16 v[156:159], a[108:111], a[24:27], v[156:159]
    s_waitcnt vmcnt(9)
    v_mfma_f32_16x16x32_bf16 v[144:147], a[112:115], a[28:31], v[144:147]
    v_mfma_f32_16x16x32_bf16 v[148:151], a[116:119], a[28:31], v[148:151]
    buffer_load_dwordx4 a[12:15], v17, s[40:43], s68 offen offset:3072 sc1
    v_mfma_f32_16x16x32_bf16 v[152:155], a[120:123], a[28:31], v[152:155]
    v_mfma_f32_16x16x32_bf16 v[156:159], a[124:127], a[28:31], v[156:159]
    s_waitcnt vmcnt(9)
    v_mfma_f32_16x16x32_bf16 v[144:147], a[128:131], a[32:35], v[144:147]
    v_mfma_f32_16x16x32_bf16 v[148:151], a[132:135], a[32:35], v[148:151]
    s_add_u32 s68, s66, 61440
    buffer_load_dwordx4 a[16:19], v17, s[40:43], s68 offen offset:0 sc1
    v_mfma_f32_16x16x32_bf16 v[152:155], a[136:139], a[32:35], v[152:155]
    v_mfma_f32_16x16x32_bf16 v[156:159], a[140:143], a[32:35], v[156:159]
    s_waitcnt vmcnt(9)
    v_mfma_f32_16x16x32_bf16 v[144:147], a[144:147], a[36:39], v[144:147]
    v_mfma_f32_16x16x32_bf16 v[148:151], a[148:151], a[36:39], v[148:151]
    buffer_load_dwordx4 a[20:23], v17, s[40:43], s68 offen offset:1024 sc1
    v_mfma_f32_16x16x32_bf16 v[152:155], a[152:155], a[36:39], v[152:155]
    v_mfma_f32_16x16x32_bf16 v[156:159], a[156:159], a[36:39], v[156:159]
    s_waitcnt vmcnt(9)
    v_mfma_f32_16x16x32_bf16 v[144:147], a[160:163], a[40:43], v[144:147]
    v_mfma_f32_16x16x32_bf16 v[148:151], a[164:167], a[40:43], v[148:151]
    buffer_load_dwordx4 a[24:27], v17, s[40:43], s68 offen offset:2048 sc1
    v_mfma_f32_16x16x32_bf16 v[152:155], a[168:171], a[40:43], v[152:155]
    v_mfma_f32_16x16x32_bf16 v[156:159], a[172:175], a[40:43], v[156:159]
    s_waitcnt vmcnt(9)
    v_mfma_f32_16x16x32_bf16 v[144:147], a[176:179], a[44:47], v[144:147]
    ds_read_b64 v[248:249], v20 offset:0
    v_mfma_f32_16x16x32_bf16 v[148:151], a[180:183], a[44:47], v[148:151]
    s_add_u32 s68, s63, 64512
    buffer_load_dwordx4 a[28:31], v17, s[40:43], s68 offen offset:0 sc1
    v_mfma_f32_16x16x32_bf16 v[152:155], a[184:187], a[44:47], v[152:155]
    ds_read_b64 v[250:251], v20 offset:512
    ds_read_b64 v[252:253], v20 offset:1024
    v_mfma_f32_16x16x32_bf16 v[156:159], a[188:191], a[44:47], v[156:159]
    s_waitcnt vmcnt(9)
    ds_read_b64 v[254:255], v20 offset:1536
    ds_read_u8 v21, v0
    ds_read_u8 v21, v0
    ds_read_u8 v21, v0
    ds_read_u8 v21, v0
    v_mfma_f32_16x16x32_bf16 v[144:147], a[192:195], a[48:51], v[144:147]
    v_mfma_f32_16x16x32_bf16 v[148:151], a[196:199], a[48:51], v[148:151]
    buffer_load_dwordx4 a[32:35], v17, s[40:43], s68 offen offset:1024 sc1
    v_mfma_f32_16x16x32_bf16 v[152:155], a[200:203], a[48:51], v[152:155]
    v_mfma_f32_16x16x32_bf16 v[156:159], a[204:207], a[48:51], v[156:159]
    s_waitcnt vmcnt(9)
    v_mfma_f32_16x16x32_bf16 v[144:147], a[208:211], a[52:55], v[144:147]
    v_mfma_f32_16x16x32_bf16 v[148:151], a[212:215], a[52:55], v[148:151]
    buffer_load_dwordx4 a[36:39], v17, s[40:43], s68 offen offset:2048 sc1
    v_mfma_f32_16x16x32_bf16 v[152:155], a[216:219], a[52:55], v[152:155]
    s_mov_b32 s57, 0
    s_load_dword s57, s[26:27], s53 offset:256
    v_mfma_f32_16x16x32_bf16 v[156:159], a[220:223], a[52:55], v[156:159]
    s_waitcnt vmcnt(9)
    s_waitcnt lgkmcnt(4)
    s_branch P2
CODE_END:
    .fill 64, 4, 0xbf810000
.section .rodata,"a"
.p2align 6
.amdhsa_kernel parallel_sum__spectral_fnet__glu_gated_glu__prompt_kernel
  .amdhsa_next_free_vgpr 512
  .amdhsa_next_free_sgpr 102
  .amdhsa_accum_offset 256
  .amdhsa_group_segment_fixed_size 0
  .amdhsa_kernarg_size 96
  .amdhsa_user_sgpr_count 2
  .amdhsa_user_sgpr_kernarg_segment_ptr 1
  .amdhsa_system_sgpr_workgroup_id_x 1
  .amdhsa_float_denorm_mode_32 3
.end_amdhsa_kernel
```
